```python
import torch

def _softmax(x, axis=-1):
    return torch.softmax(x, dim=axis)
def _gelu(x):
    return torch.nn.functional.gelu(x, approximate="tanh")
def _silu(x):
    return torch.nn.functional.silu(x)
def _sigmoid(x):
    return torch.sigmoid(x)
def _layernorm(x, axis=-1, eps=1e-5):
    m = x.mean(dim=axis, keepdim=True)
    v = x.var(dim=axis, keepdim=True, unbiased=False)
    return (x - m) / torch.sqrt(v + eps)
def _scatter_add(tgt, idx, src, axis=0):
    return tgt.clone().index_add_(axis, idx, src)
def _segment_sum(src, seg, n):
    out = torch.zeros((n,) + src.shape[1:], dtype=src.dtype)
    return out.index_add_(0, seg, src)
def _pad(x, pw):
    flat = tuple(v for pair in reversed(pw) for v in pair)
    return torch.nn.functional.pad(x, flat)

kernel_name = 'recurrent_scan__sliding_local_dilated__dense_activation_mish__prompt'

def setup_inputs():

    _w = (lambda a: (lambda t: t.to(torch.bfloat16) if t.is_floating_point() else t)(torch.as_tensor(a)))
    def _A_setup():
        B, S, D = 1, 2048, 448
        return {
            "x": _w((lambda *s: torch.randn(*s, dtype=torch.bfloat16) * 0.05)(B, S, D)),
            "wqkv": _w((lambda *s: torch.randn(*s, dtype=torch.bfloat16) * 0.2)(D, 3 * D)),
            "wo": _w((lambda *s: torch.randn(*s, dtype=torch.bfloat16) * 0.2)(D, D)),
        }
    _A_in = _A_setup()

    def _B_setup():
        B, S, D, F = 1, 2048, 448, 1792
        return {
            "x": _w((lambda *s: torch.randn(*s, dtype=torch.bfloat16) * 0.05)(B, S, D)),
            "w1": _w((lambda *s: torch.randn(*s, dtype=torch.bfloat16) * 0.8)(D, F) * (D ** -0.5)),
            "b1": _w((lambda *s: torch.randn(*s, dtype=torch.bfloat16) * 0.4)(F)),
            "w2": _w((lambda *s: torch.randn(*s, dtype=torch.bfloat16) * 0.1)(F, D) * (F ** -0.5)),
        }
    _B_in = _B_setup()

    return {
        "A_x": _A_in["x"],
        "A_wqkv": _A_in["wqkv"],
        "A_wo": _A_in["wo"],
        "B_x": _B_in["x"],
        "B_w1": _B_in["w1"],
        "B_b1": _B_in["b1"],
        "B_w2": _B_in["w2"],
    }

def reference(A_x, A_wqkv, A_wo, B_x, B_w1, B_b1, B_w2):
    def _A_ref(x, wqkv, wo):
        B, S, D = x.shape
        H = 16; Dh = D // H
        W, dil = 8, 2
        qkv = (lambda x, *d: x.permute(*d))((x @ wqkv).reshape(B, S, 3, H, Dh), 2, 0, 3, 1, 4)
        q, k, v = qkv[0], qkv[1], qkv[2]
        scale = Dh ** -0.5
        pos = torch.arange(S)
        off = torch.arange(W) * dil
        idx = pos[:, None] - off[None, :]
        mask = idx >= 0
        idx_c = torch.where(mask, idx, 0).reshape(-1)
        kg = k[:, :, idx_c, :].reshape(B, H, S, W, Dh)
        vg = v[:, :, idx_c, :].reshape(B, H, S, W, Dh)
        logits = torch.einsum("bhsd,bhswd->bhsw", q, kg) * scale
        logits = torch.where(mask[None, None, :, :], logits, -1e9)
        attn = _softmax(logits, axis=-1)
        o = torch.einsum("bhsw,bhswd->bhsd", attn, vg)
        return (lambda x, *d: x.permute(*d))(o, 0, 2, 1, 3).reshape(B, S, D) @ wo

    def _B_ref(x, w1, b1, w2):
        h = torch.einsum("bsd,df->bsf", x, w1) + b1
        sp = torch.log1p(torch.exp(-torch.abs(h))) + torch.where(h > 0, h, torch.zeros_like(h))
        act = h * torch.tanh(sp)
        return torch.einsum("bsf,fd->bsd", act, w2)

    x = A_x
    xn = _layernorm(x, axis=-1)
    s = _A_ref(xn, A_wqkv, A_wo)
    g = _silu(_B_ref(xn, B_w1, B_b1, B_w2))
    return x + s * g
```

```asm
; @launch grid=(256,1,1) block=(256,1,1) lds=163840
.amdgcn_target "amdgcn-amd-amdhsa--gfx950"
.text
.globl recurrent_scan__sliding_local_dilated__dense_activation_mish__prompt_kernel
.p2align 8
.type recurrent_scan__sliding_local_dilated__dense_activation_mish__prompt_kernel,@function
recurrent_scan__sliding_local_dilated__dense_activation_mish__prompt_kernel:
	s_cmp_ge_u32 s2, 256
	s_cbranch_scc1 L_f_end
	s_load_dwordx16 s[64:79], s[0:1], 0
	s_load_dwordx4 s[80:83], s[0:1], 64
	v_lshrrev_b32 v1, 6, v0
	v_and_b32 v0, 63, v0
	v_readfirstlane_b32 s32, v1
	s_and_b32 s40, s2, 7
	s_lshr_b32 s41, s2, 3
	s_and_b32 s42, s40, 1
	s_lshl_b32 s42, s42, 3
	s_and_b32 s43, s41, 7
	s_add_u32 s33, s42, s43
	s_lshr_b32 s37, s41, 3
	s_lshr_b32 s42, s40, 1
	s_lshl_b32 s43, s42, 1
	s_and_b32 s44, s37, 1
	s_cmp_eq_u32 s42, 3
	s_cselect_b32 s45, 1, 0
	s_lshr_b32 s46, s37, 1
	s_and_b32 s45, s45, s46
	s_xor_b32 s44, s44, s45
	s_add_u32 s34, s43, s44
	s_mov_b32 s3, s41
	s_getpc_b64 s[50:51]
L_pc:
	s_lshl_b32 s49, s41, 2
	s_add_u32 s49, s49, s32
	s_mul_i32 s49, s49, 384
	v_lshlrev_b32 v2, 7, v0
	v_add_u32 v2, s49, v2
	s_mov_b32 s52, L_code_end-L_pc-4
	v_min_u32 v2, s52, v2
	v_add_co_u32 v2, vcc, s50, v2
	v_mov_b32 v3, s51
	s_nop 0
	v_addc_co_u32 v3, vcc, 0, v3, vcc
	s_mov_b64 exec, 7
	global_load_dword v100, v[2:3], off
	s_mov_b64 exec, -1
	s_cmp_ge_u32 s37, 2
	s_cbranch_scc1 L_f_attn
	s_lshl_b32 s49, s33, 7
	s_lshl_b32 s50, s32, 5
	s_add_u32 s49, s49, s50
	s_mul_i32 s40, s49, 896
	s_lshl_b32 s41, s32, 12
	s_add_u32 s41, s41, 65536
	s_and_b32 s48, s34, 1
	s_mul_i32 s46, s34, 224
	s_lshl_b32 s49, s46, 1
	s_lshl_b32 s50, s48, 6
	s_add_u32 s45, s49, s50
	s_mul_i32 s42, s32, 57344
	s_add_u32 s42, s42, s45
	s_lshl_b32 s43, s32, 11
	s_mul_i32 s50, s48, 512
	s_sub_u32 s51, 384, s50
	v_lshrrev_b32 v1, 3, v0
	v_and_b32 v2, 7, v0
	v_lshrrev_b32 v3, 1, v1
	v_xor_b32 v4, v3, v2
	v_lshlrev_b32 v4, 4, v4
	v_mul_u32_u24 v5, 896, v1
	v_add_u32 v244, v5, v4
	v_add_u32 v246, 12288, v244
	v_xor_b32 v4, 64, v4
	v_add_u32 v245, v5, v4
	v_add_u32 v247, 18432, v245
	v_add_u32 v245, 6144, v245
	v_and_b32 v3, 1, v3
	v_lshlrev_b32 v3, 2, v3
	v_xor_b32 v3, v3, v2
	v_lshlrev_b32 v3, 4, v3
	v_mul_u32_u24 v5, 3584, v1
	v_add_u32 v6, v5, v3
	v_add_u32 v7, 27648, v6
	s_mov_b32 s58, s51
	s_and_b32 s49, s3, 7
	s_sub_u32 s50, s49, 7
	s_cmp_ge_u32 s49, 7
	s_cselect_b32 s49, s50, s49
	s_lshl_b32 s84, s49, 7
	s_mul_i32 s91, s84, 1792
	s_add_u32 s91, s91, s42
	s_lshl_b32 s49, s46, 1
	s_mul_i32 s50, s48, 384
	s_sub_u32 s50, 384, s50
	s_add_u32 s52, s49, s50
	s_lshl_b32 s50, s48, 6
	s_sub_u32 s49, s49, s50
	s_lshl_b32 s50, s32, 7
	s_add_u32 s55, s49, s50
	s_add_u32 s56, s50, 133120
	v_lshlrev_b32 v242, 2, v0
	s_mov_b32 s6, 0x1c0000
	s_mov_b32 s7, 0x20000
	s_mov_b32 s10, 0x188000
	s_mov_b32 s11, 0x20000
	s_mov_b32 s30, 0xe00
	s_mov_b32 s31, 0x20000
	s_waitcnt lgkmcnt(0)
	s_mov_b32 s4, s64
	s_mov_b32 s5, s65
	s_mov_b32 s8, s72
	s_mov_b32 s9, s73
	s_add_u32 m0, s41, 0
	s_add_u32 s47, s40, s84
	buffer_load_dwordx4 v244, s[4:7], s47 offen offset:0 lds
	buffer_load_dwordx4 v245, s[4:7], s47 offen offset:1024 lds
	buffer_load_dwordx4 v246, s[4:7], s47 offen offset:2048 lds
	buffer_load_dwordx4 v247, s[4:7], s47 offen offset:3072 lds
	s_add_u32 m0, s43, 0
	s_nop 0
	buffer_load_dwordx4 v6, s[8:11], s91 offen offset:0 lds
	buffer_load_dwordx4 v7, s[8:11], s91 offen offset:1024 lds
	s_mov_b32 s28, s74
	s_mov_b32 s29, s75
	s_mov_b32 s12, s82
	s_add_u32 s85, s84, 128
	s_mov_b32 s13, s83
	s_mov_b32 s14, 0xa11000
	s_mov_b32 s15, 0x20000
	s_cmp_eq_u32 s85, 896
	s_cselect_b32 s85, 0, s85
	s_mov_b32 s16, s76
	s_mov_b32 s17, s77
	s_mov_b32 s18, 0x188000
	s_mul_i32 s92, s85, 1792
	s_mov_b32 s19, 0x20000
	s_mov_b32 s20, s68
	s_mov_b32 s21, s69
	s_add_u32 s92, s92, s42
	s_mov_b32 s22, 0x62000
	s_mov_b32 s23, 0x20000
	s_mov_b32 s24, s78
	s_add_u32 m0, s43, 8192
	s_mov_b32 s25, s79
	s_mov_b32 s26, 0x1c0000
	s_mov_b32 s27, 0x20000
	buffer_load_dwordx4 v6, s[8:11], s92 offen offset:0 lds
	s_mov_b32 s38, s80
	s_mov_b32 s39, s81
	s_mul_i32 s49, s3, 37
	buffer_load_dwordx4 v7, s[8:11], s92 offen offset:1024 lds
	s_lshr_b32 s49, s49, 8
	s_mul_i32 s50, s49, 7
	s_sub_u32 s36, s3, s50
	s_add_u32 s86, s85, 128
	s_and_b32 s50, s2, 7
	s_lshr_b32 s35, s50, 1
	s_and_b32 s50, s50, 1
	s_cmp_eq_u32 s86, 896
	s_cselect_b32 s86, 0, s86
	s_xor_b32 s50, s50, 1
	s_lshl_b32 s50, s50, 2
	s_add_u32 s35, s35, s50
	s_mul_i32 s93, s86, 1792
	s_lshl_b32 s35, s35, 2
	s_add_u32 s35, s35, s49
	s_lshl_b32 s83, s36, 7
	s_add_u32 s93, s93, s42
	s_cmp_ge_u32 s3, 28
	s_cselect_b32 s83, 0x7f000000, s83
	s_mul_i32 s73, s32, 57344
	s_mov_b32 s18, 1605632
	s_add_u32 m0, s43, 16384
	s_mov_b32 s72, 200704
	s_mov_b32 s74, 28672
	s_mov_b32 s75, 28672
	buffer_load_dwordx4 v6, s[8:11], s93 offen offset:0 lds
	s_cmp_eq_u32 s32, 3
	s_cselect_b32 s16, s20, s16
	s_cselect_b32 s17, s21, s17
	s_cselect_b32 s18, 401408, s18
	s_cselect_b32 s72, 50176, s72
	s_cselect_b32 s73, 0, s73
	s_cselect_b32 s74, 25088, s74
	s_cselect_b32 s75, 0, s75
	s_add_u32 s73, s73, s83
	s_add_u32 s76, s74, s75
	buffer_load_dwordx4 v7, s[8:11], s93 offen offset:1024 lds
	s_add_u32 s74, s74, s73
	s_add_u32 s75, s75, s73
	s_add_u32 s76, s76, s73
	s_add_u32 m0, s41, 16384
	s_lshl_b32 s82, s32, 3
	s_or_b32 s82, s82, 0x80000
	s_bfe_u32 s77, 0xff140706, s82
	s_cmp_eq_u32 s77, 255
	s_cselect_b32 s77, 16384, s77
	s_add_u32 s47, s40, s85
	s_bfe_u32 s78, 0xff232215, s82
	s_cmp_eq_u32 s78, 255
	s_cselect_b32 s78, 16384, s78
	s_bfe_u32 s79, 0xffff3130, s82
	buffer_load_dwordx4 v244, s[4:7], s47 offen offset:0 lds
	s_cmp_eq_u32 s79, 255
	s_cselect_b32 s79, 16384, s79
	s_lshl_b32 s80, s32, 12
	s_add_u32 s80, s80, 65536
	buffer_load_dwordx4 v245, s[4:7], s47 offen offset:1024 lds
	s_lshl_b32 s81, s32, 14
	s_mov_b32 s20, s38
	s_mov_b32 s21, s39
	buffer_load_dwordx4 v246, s[4:7], s47 offen offset:2048 lds
	s_mov_b32 s22, 0x100
	s_mov_b32 s23, 0x20000
	s_mul_i32 s82, s33, 4352
	buffer_load_dwordx4 v247, s[4:7], s47 offen offset:3072 lds
	s_add_u32 s82, s82, 10485760
	v_mov_b32 v240, 2.0
	v_writelane_b32 v240, s82, 0
	s_mov_b32 m0, s56
	s_mov_b32 exec_hi, 0
	buffer_load_dword v242, s[28:31], s55 offen lds
	s_mov_b32 exec_hi, -1
	s_lshr_b32 s82, s35, 1
	s_mul_i32 s82, s82, 4352
	s_add_u32 s82, s82, 10485760
	s_add_u32 m0, s41, 32768
	v_mov_b32 v241, 2.0
	v_writelane_b32 v241, s82, 0
	s_cmp_eq_u32 s32, 3
	s_cselect_b32 s82, 512, 0
	s_add_u32 s47, s40, s86
	v_add_u32 v241, s82, v241
	v_and_b32 v3, 31, v0
	v_lshlrev_b32 v3, 1, v3
	buffer_load_dwordx4 v244, s[4:7], s47 offen offset:0 lds
	s_lshl_b32 s49, s48, 7
	s_add_u32 s49, s49, 133120
	v_add_u32 v10, s49, v3
	buffer_load_dwordx4 v245, s[4:7], s47 offen offset:1024 lds
	s_mul_i32 s49, s48, 320
	s_sub_u32 s49, 133504, s49
	v_add_u32 v11, s49, v3
	buffer_load_dwordx4 v246, s[4:7], s47 offen offset:2048 lds
	v_lshrrev_b32 v20, 5, v0
	v_and_b32 v21, 31, v0
	v_lshrrev_b32 v3, 1, v21
	buffer_load_dwordx4 v247, s[4:7], s47 offen offset:3072 lds
	v_and_b32 v3, 7, v3
	v_lshl_add_u32 v4, v21, 7, s41
	v_and_b32 v5, 15, v0
	s_add_u32 s87, s86, 128
	v_lshrrev_b32 v5, 2, v5
	v_lshl_add_u32 v22, v20, 3, v5
	v_lshlrev_b32 v22, 7, v22
	s_cmp_eq_u32 s87, 896
	s_cselect_b32 s87, 0, s87
	v_lshrrev_b32 v5, 1, v5
	v_lshl_or_b32 v22, v5, 6, v22
	v_lshrrev_b32 v5, 4, v0
	v_and_b32 v5, 1, v5
	s_mul_i32 s94, s87, 1792
	v_lshl_or_b32 v22, v5, 5, v22
	v_and_b32 v5, 3, v0
	v_lshl_or_b32 v22, v5, 3, v22
	s_add_u32 s94, s94, s42
	s_add_u32 s49, s32, 0
	s_and_b32 s49, s49, 3
	s_lshl_b32 s50, s49, 1
	s_add_u32 s88, s87, 128
	v_add_u32 v5, s50, v20
	v_xor_b32 v5, v5, v3
	v_lshl_add_u32 v248, v5, 4, v4
	s_cmp_eq_u32 s88, 896
	s_cselect_b32 s88, 0, s88
	s_lshl_b32 s50, s49, 11
	v_add_u32 v12, s50, v22
	v_xor_b32 v13, 64, v12
	s_mul_i32 s95, s88, 1792
	s_add_u32 s49, s32, 1
	s_and_b32 s49, s49, 3
	s_lshl_b32 s50, s49, 1
	s_add_u32 s95, s95, s42
	v_add_u32 v5, s50, v20
	v_xor_b32 v5, v5, v3
	v_lshl_add_u32 v249, v5, 4, v4
	s_add_u32 s89, s88, 128
	s_lshl_b32 s50, s49, 11
	v_add_u32 v14, s50, v22
	v_xor_b32 v15, 64, v14
	s_cmp_eq_u32 s89, 896
	s_cselect_b32 s89, 0, s89
	s_add_u32 s49, s32, 2
	s_and_b32 s49, s49, 3
	s_lshl_b32 s50, s49, 1
	s_mul_i32 s96, s89, 1792
	v_add_u32 v5, s50, v20
	v_xor_b32 v5, v5, v3
	v_lshl_add_u32 v250, v5, 4, v4
	s_add_u32 s96, s96, s42
	s_lshl_b32 s50, s49, 11
	v_add_u32 v16, s50, v22
	v_xor_b32 v17, 64, v16
	s_add_u32 s90, s89, 128
	s_add_u32 s49, s32, 3
	s_and_b32 s49, s49, 3
	s_lshl_b32 s50, s49, 1
	s_cmp_eq_u32 s90, 896
	s_cselect_b32 s90, 0, s90
	v_add_u32 v5, s50, v20
	v_xor_b32 v5, v5, v3
	v_lshl_add_u32 v251, v5, 4, v4
	s_mul_i32 s97, s90, 1792
	s_lshl_b32 s50, s49, 11
	v_add_u32 v18, s50, v22
	v_xor_b32 v19, 64, v18
	s_add_u32 s97, s97, s42
	v_lshrrev_b32 v5, 4, v0
	v_xor_b32 v5, v5, v0
	v_and_b32 v5, 1, v5
	v_cmp_eq_u32 vcc, 0, v5
	v_mov_b32 v3, 0x3f803f80
	v_mov_b32 v4, 0
	v_cndmask_b32 v3, v4, v3, vcc
	v_accvgpr_write_b32 a72, v3
	v_accvgpr_write_b32 a73, v3
	v_accvgpr_write_b32 a74, v3
	v_accvgpr_write_b32 a75, v3
	v_mov_b32 v3, 0x3f803f80
	v_accvgpr_write_b32 a76, v3
	v_accvgpr_write_b32 a77, v3
	v_accvgpr_write_b32 a78, v3
	v_accvgpr_write_b32 a79, v3
	s_mov_b32 s60, 0x30003
	s_mov_b32 s61, 0x30003
	s_mov_b32 s64, 0xaaaaaaaa
	s_mov_b32 s65, 0xaaaaaaaa
	s_mov_b32 s66, 0xcccccccc
	s_mov_b32 s67, 0xcccccccc
	s_mov_b32 s68, 0xff00ff00
	s_mov_b32 s69, 0xff00ff00
	s_mov_b32 s70, 0xffff0000
	s_mov_b32 s71, 0xffff0000
	v_and_b32 v5, 1, v0
	v_lshrrev_b32 v200, 4, v0
	v_lshlrev_b32 v200, 4, v200
	v_lshl_or_b32 v200, v5, 6, v200
	s_lshl_b32 s49, s32, 8
	s_add_u32 s49, s49, 131072
	v_add_u32 v200, s49, v200
	v_lshlrev_b32 v201, 2, v21
	v_add_u32 v201, 131072, v201
	v_lshlrev_b32 v231, 4, v0
	s_lshl_b32 s49, s33, 1
	s_lshr_b32 s50, s32, 1
	s_add_u32 s49, s49, s50
	s_mul_i32 s44, s49, 229376
	s_and_b32 s50, s32, 1
	s_lshl_b32 s50, s50, 10
	s_add_u32 s44, s44, s50
	s_add_u32 s44, s44, 0
	s_lshl_b32 s49, s45, 6
	s_add_u32 s53, s44, s49
	s_lshl_b32 s49, s52, 6
	s_add_u32 s54, s44, s49
	s_waitcnt vmcnt(13)
	s_barrier
	ds_read_b128 v[24:27], v248 offset:0
	ds_read_b128 v[28:31], v249 offset:0
	ds_read_b128 v[32:35], v250 offset:0
	ds_read_b128 v[36:39], v251 offset:0
	ds_read_b64_tr_b16 a[8:9], v12 offset:0
	ds_read_b64_tr_b16 a[10:11], v12 offset:512
	ds_read_b64_tr_b16 a[12:13], v13 offset:0
	ds_read_b64_tr_b16 a[14:15], v13 offset:512
	ds_read_b64_tr_b16 a[16:17], v14 offset:0
	ds_read_b64_tr_b16 a[18:19], v14 offset:512
	ds_read_b64_tr_b16 a[20:21], v15 offset:0
	ds_read_b64_tr_b16 a[22:23], v15 offset:512
	ds_read_b64_tr_b16 a[24:25], v16 offset:0
	ds_read_b64_tr_b16 a[26:27], v16 offset:512
	ds_read_b64_tr_b16 a[28:29], v17 offset:0
	ds_read_b64_tr_b16 a[30:31], v17 offset:512
	ds_read_b64_tr_b16 a[32:33], v18 offset:0
	ds_read_b64_tr_b16 a[34:35], v18 offset:512
	ds_read_b64_tr_b16 a[36:37], v19 offset:0
	ds_read_b64_tr_b16 a[38:39], v19 offset:512
	s_waitcnt vmcnt(9)
	s_waitcnt lgkmcnt(0)
	s_barrier
	v_mfma_f32_32x32x16_bf16 v[136:151], a[8:11], v[24:27], 0
	s_waitcnt vmcnt(5)
	s_add_u32 m0, s41, 49152
	ds_read_b128 v[40:43], v248 offset:16384
	s_add_u32 s47, s40, s87
	ds_read_b128 v[44:47], v249 offset:16384
	buffer_load_dwordx4 v244, s[4:7], s47 offen offset:0 lds
	v_mfma_f32_32x32x16_bf16 v[168:183], a[76:79], v[24:27], 0
	ds_read_b128 v[48:51], v250 offset:16384
	ds_read_b128 v[52:55], v251 offset:16384
	buffer_load_dwordx4 v245, s[4:7], s47 offen offset:1024 lds
	ds_read_b64_tr_b16 a[40:41], v12 offset:8192
	ds_read_b64_tr_b16 a[42:43], v12 offset:8704
	v_mfma_f32_32x32x16_bf16 v[152:167], a[12:15], v[24:27], 0
	buffer_load_dwordx4 v246, s[4:7], s47 offen offset:2048 lds
	ds_read_b64_tr_b16 a[44:45], v13 offset:8192
	ds_read_b64_tr_b16 a[46:47], v13 offset:8704
	buffer_load_dwordx4 v247, s[4:7], s47 offen offset:3072 lds
	v_mfma_f32_32x32x16_bf16 v[184:199], v[24:27], v[24:27], 0
	ds_read_b64_tr_b16 a[48:49], v14 offset:8192
	s_add_u32 m0, s43, 24576
	ds_read_b64_tr_b16 a[50:51], v14 offset:8704
	ds_read_b64_tr_b16 a[52:53], v15 offset:8192
	buffer_load_dwordx4 v6, s[8:11], s94 offen offset:0 lds
	v_mfma_f32_16x16x32_bf16 a[0:3], a[8:11], a[72:75], 0
	ds_read_b64_tr_b16 a[54:55], v15 offset:8704
	v_mfma_f32_16x16x32_bf16 a[4:7], a[12:15], a[72:75], 0
	ds_read_b64_tr_b16 a[56:57], v16 offset:8192
	v_mfma_f32_32x32x16_bf16 v[136:151], a[16:19], v[28:31], v[136:151]
	buffer_load_dwordx4 v7, s[8:11], s94 offen offset:1024 lds
	ds_read_b64_tr_b16 a[58:59], v16 offset:8704
	s_add_u32 m0, s43, 32768
	ds_read_b64_tr_b16 a[60:61], v17 offset:8192
	buffer_load_dwordx4 v6, s[8:11], s95 offen offset:0 lds
	v_mfma_f32_32x32x16_bf16 v[168:183], a[76:79], v[28:31], v[168:183]
	ds_read_b64_tr_b16 a[62:63], v17 offset:8704
	ds_read_b64_tr_b16 a[64:65], v18 offset:8192
	buffer_load_dwordx4 v7, s[8:11], s95 offen offset:1024 lds
	ds_read_b64_tr_b16 a[66:67], v18 offset:8704
	s_add_u32 m0, s41, 0
	v_mfma_f32_32x32x16_bf16 v[152:167], a[20:23], v[28:31], v[152:167]
	ds_read_b64_tr_b16 a[68:69], v19 offset:8192
	s_add_u32 s47, s40, s88
	ds_read_b64_tr_b16 a[70:71], v19 offset:8704
	buffer_load_dwordx4 v244, s[4:7], s47 offen offset:0 lds
	v_mfma_f32_32x32x16_bf16 v[184:199], v[28:31], v[28:31], v[184:199]
	buffer_load_dwordx4 v245, s[4:7], s47 offen offset:1024 lds
	buffer_load_dwordx4 v246, s[4:7], s47 offen offset:2048 lds
	buffer_load_dwordx4 v247, s[4:7], s47 offen offset:3072 lds
	s_add_u32 m0, s43, 40960
	v_mfma_f32_32x32x16_bf16 v[136:151], a[24:27], v[32:35], v[136:151]
	buffer_load_dwordx4 v6, s[8:11], s96 offen offset:0 lds
	buffer_load_dwordx4 v7, s[8:11], s96 offen offset:1024 lds
	v_mfma_f32_32x32x16_bf16 v[168:183], a[76:79], v[32:35], v[168:183]
	v_mfma_f32_32x32x16_bf16 v[152:167], a[28:31], v[32:35], v[152:167]
	v_mfma_f32_32x32x16_bf16 v[184:199], v[32:35], v[32:35], v[184:199]
	v_mfma_f32_32x32x16_bf16 v[136:151], a[32:35], v[36:39], v[136:151]
	v_mfma_f32_32x32x16_bf16 v[168:183], a[76:79], v[36:39], v[168:183]
	v_mfma_f32_32x32x16_bf16 v[152:167], a[36:39], v[36:39], v[152:167]
	v_mfma_f32_32x32x16_bf16 v[184:199], v[36:39], v[36:39], v[184:199]
	s_waitcnt vmcnt(14)
	ds_read_b128 v[56:59], v248 offset:32768
	ds_read_b128 v[60:63], v249 offset:32768
	ds_read_b128 v[64:67], v250 offset:32768
	ds_read_b128 v[68:71], v251 offset:32768
	ds_read_b64_tr_b16 a[8:9], v12 offset:16384
	s_add_u32 m0, s41, 16384
	ds_read_b64_tr_b16 a[10:11], v12 offset:16896
	s_waitcnt lgkmcnt(6)
	v_mfma_f32_32x32x16_bf16 v[136:151], a[40:43], v[40:43], v[136:151]
	s_add_u32 s47, s40, s89
	ds_read_b64_tr_b16 a[12:13], v13 offset:16384
	ds_read_b64_tr_b16 a[14:15], v13 offset:16896
	buffer_load_dwordx4 v244, s[4:7], s47 offen offset:0 lds
	ds_read_b64_tr_b16 a[16:17], v14 offset:16384
	v_mfma_f32_32x32x16_bf16 v[168:183], a[76:79], v[40:43], v[168:183]
	buffer_load_dwordx4 v245, s[4:7], s47 offen offset:1024 lds
	ds_read_b64_tr_b16 a[18:19], v14 offset:16896
	ds_read_b64_tr_b16 a[20:21], v15 offset:16384
	buffer_load_dwordx4 v246, s[4:7], s47 offen offset:2048 lds
	v_mfma_f32_32x32x16_bf16 v[152:167], a[44:47], v[40:43], v[152:167]
	ds_read_b64_tr_b16 a[22:23], v15 offset:16896
	ds_read_b64_tr_b16 a[24:25], v16 offset:16384
	buffer_load_dwordx4 v247, s[4:7], s47 offen offset:3072 lds
	ds_read_b64_tr_b16 a[26:27], v16 offset:16896
	s_add_u32 m0, s43, 49152
	v_mfma_f32_32x32x16_bf16 v[184:199], v[40:43], v[40:43], v[184:199]
	ds_read_b64_tr_b16 a[28:29], v17 offset:16384
	ds_read_b64_tr_b16 a[30:31], v17 offset:16896
	buffer_load_dwordx4 v6, s[8:11], s97 offen offset:0 lds
	ds_read_b64_tr_b16 a[32:33], v18 offset:16384
	ds_read_b64_tr_b16 a[34:35], v18 offset:16896
	v_mfma_f32_16x16x32_bf16 a[0:3], a[40:43], a[72:75], a[0:3]
	buffer_load_dwordx4 v7, s[8:11], s97 offen offset:1024 lds
	v_mfma_f32_16x16x32_bf16 a[4:7], a[44:47], a[72:75], a[4:7]
	v_mfma_f32_32x32x16_bf16 v[136:151], a[48:51], v[44:47], v[136:151]
	ds_read_b64_tr_b16 a[36:37], v19 offset:16384
	s_add_u32 m0, s43, 57344
	ds_read_b64_tr_b16 a[38:39], v19 offset:16896
	s_add_u32 s47, s91, 128
	buffer_load_dwordx4 v6, s[8:11], s47 offen offset:0 lds
	v_mfma_f32_32x32x16_bf16 v[168:183], a[76:79], v[44:47], v[168:183]
	buffer_load_dwordx4 v7, s[8:11], s47 offen offset:1024 lds
	v_mfma_f32_32x32x16_bf16 v[152:167], a[52:55], v[44:47], v[152:167]
	v_mfma_f32_32x32x16_bf16 v[184:199], v[44:47], v[44:47], v[184:199]
	v_mfma_f32_32x32x16_bf16 v[136:151], a[56:59], v[48:51], v[136:151]
	v_mfma_f32_32x32x16_bf16 v[168:183], a[76:79], v[48:51], v[168:183]
	v_mfma_f32_32x32x16_bf16 v[152:167], a[60:63], v[48:51], v[152:167]
	v_mfma_f32_32x32x16_bf16 v[184:199], v[48:51], v[48:51], v[184:199]
	v_mfma_f32_32x32x16_bf16 v[136:151], a[64:67], v[52:55], v[136:151]
	v_mfma_f32_32x32x16_bf16 v[168:183], a[76:79], v[52:55], v[168:183]
	v_mfma_f32_32x32x16_bf16 v[152:167], a[68:71], v[52:55], v[152:167]
	v_mfma_f32_32x32x16_bf16 v[184:199], v[52:55], v[52:55], v[184:199]
	s_waitcnt vmcnt(14)
	s_waitcnt lgkmcnt(0)
	s_barrier
	v_mfma_f32_32x32x16_bf16 v[136:151], a[8:11], v[56:59], v[136:151]
	ds_read_b128 v[72:75], v248 offset:49152
	s_add_u32 m0, s41, 32768
	ds_read_b128 v[76:79], v249 offset:49152
	ds_read_b128 v[80:83], v250 offset:49152
	s_add_u32 s47, s40, s90
	ds_read_b128 v[84:87], v251 offset:49152
	v_mfma_f32_32x32x16_bf16 v[168:183], a[76:79], v[56:59], v[168:183]
	ds_read_b64_tr_b16 a[40:41], v12 offset:24576
	ds_read_b64_tr_b16 a[42:43], v12 offset:25088
	ds_read_b64_tr_b16 a[44:45], v13 offset:24576
	buffer_load_dwordx4 v244, s[4:7], s47 offen offset:0 lds
	ds_read_b64_tr_b16 a[46:47], v13 offset:25088
	v_mfma_f32_32x32x16_bf16 v[152:167], a[12:15], v[56:59], v[152:167]
	ds_read_b64_tr_b16 a[48:49], v14 offset:24576
	ds_read_b64_tr_b16 a[50:51], v14 offset:25088
	ds_read_b64_tr_b16 a[52:53], v15 offset:24576
	buffer_load_dwordx4 v245, s[4:7], s47 offen offset:1024 lds
	ds_read_b64_tr_b16 a[54:55], v15 offset:25088
	v_mfma_f32_32x32x16_bf16 v[184:199], v[56:59], v[56:59], v[184:199]
	ds_read_b64_tr_b16 a[56:57], v16 offset:24576
	ds_read_b64_tr_b16 a[58:59], v16 offset:25088
	ds_read_b64_tr_b16 a[60:61], v17 offset:24576
	ds_read_b64_tr_b16 a[62:63], v17 offset:25088
	buffer_load_dwordx4 v246, s[4:7], s47 offen offset:2048 lds
	v_mfma_f32_16x16x32_bf16 a[0:3], a[8:11], a[72:75], a[0:3]
	ds_read_b64_tr_b16 a[64:65], v18 offset:24576
	v_mfma_f32_16x16x32_bf16 a[4:7], a[12:15], a[72:75], a[4:7]
	ds_read_b64_tr_b16 a[66:67], v18 offset:25088
	v_mfma_f32_32x32x16_bf16 v[136:151], a[16:19], v[60:63], v[136:151]
	ds_read_b64_tr_b16 a[68:69], v19 offset:24576
	ds_read_b64_tr_b16 a[70:71], v19 offset:25088
	buffer_load_dwordx4 v247, s[4:7], s47 offen offset:3072 lds
	s_add_u32 m0, s43, 0
	v_mfma_f32_32x32x16_bf16 v[168:183], a[76:79], v[60:63], v[168:183]
	s_add_u32 s47, s92, 128
	v_mfma_f32_32x32x16_bf16 v[152:167], a[20:23], v[60:63], v[152:167]
	v_mfma_f32_32x32x16_bf16 v[184:199], v[60:63], v[60:63], v[184:199]
	buffer_load_dwordx4 v6, s[8:11], s47 offen offset:0 lds
	v_mfma_f32_32x32x16_bf16 v[136:151], a[24:27], v[64:67], v[136:151]
	v_mfma_f32_32x32x16_bf16 v[168:183], a[76:79], v[64:67], v[168:183]
	v_mfma_f32_32x32x16_bf16 v[152:167], a[28:31], v[64:67], v[152:167]
	buffer_load_dwordx4 v7, s[8:11], s47 offen offset:1024 lds
	v_mfma_f32_32x32x16_bf16 v[184:199], v[64:67], v[64:67], v[184:199]
	v_mfma_f32_32x32x16_bf16 v[136:151], a[32:35], v[68:71], v[136:151]
	v_mfma_f32_32x32x16_bf16 v[168:183], a[76:79], v[68:71], v[168:183]
	s_add_u32 m0, s43, 8192
	v_mfma_f32_32x32x16_bf16 v[152:167], a[36:39], v[68:71], v[152:167]
	s_add_u32 s47, s93, 128
	v_mfma_f32_32x32x16_bf16 v[184:199], v[68:71], v[68:71], v[184:199]
	s_waitcnt vmcnt(16)
	ds_read_b128 v[88:91], v248 offset:0
	ds_read_b128 v[92:95], v249 offset:0
	ds_read_b128 v[96:99], v250 offset:0
	ds_read_b128 v[100:103], v251 offset:0
	ds_read_b64_tr_b16 a[8:9], v12 offset:32768
	ds_read_b64_tr_b16 a[10:11], v12 offset:33280
	ds_read_b64_tr_b16 a[12:13], v13 offset:32768
	s_waitcnt lgkmcnt(7)
	v_mfma_f32_32x32x16_bf16 v[136:151], a[40:43], v[72:75], v[136:151]
	ds_read_b64_tr_b16 a[14:15], v13 offset:33280
	ds_read_b64_tr_b16 a[16:17], v14 offset:32768
	ds_read_b64_tr_b16 a[18:19], v14 offset:33280
	ds_read_b64_tr_b16 a[20:21], v15 offset:32768
	ds_read_b64_tr_b16 a[22:23], v15 offset:33280
	ds_read_b64_tr_b16 a[24:25], v16 offset:32768
	v_mfma_f32_32x32x16_bf16 v[168:183], a[76:79], v[72:75], v[168:183]
	ds_read_b64_tr_b16 a[26:27], v16 offset:33280
	ds_read_b64_tr_b16 a[28:29], v17 offset:32768
	ds_read_b64_tr_b16 a[30:31], v17 offset:33280
	ds_read_b64_tr_b16 a[32:33], v18 offset:32768
	buffer_load_dwordx4 v6, s[8:11], s47 offen offset:0 lds
	v_mfma_f32_32x32x16_bf16 v[152:167], a[44:47], v[72:75], v[152:167]
	ds_read_b64_tr_b16 a[34:35], v18 offset:33280
	ds_read_b64_tr_b16 a[36:37], v19 offset:32768
	ds_read_b64_tr_b16 a[38:39], v19 offset:33280
	v_mfma_f32_32x32x16_bf16 v[184:199], v[72:75], v[72:75], v[184:199]
	buffer_load_dwordx4 v7, s[8:11], s47 offen offset:1024 lds
	v_mfma_f32_16x16x32_bf16 a[0:3], a[40:43], a[72:75], a[0:3]
	v_mfma_f32_16x16x32_bf16 a[4:7], a[44:47], a[72:75], a[4:7]
	v_mfma_f32_32x32x16_bf16 v[136:151], a[48:51], v[76:79], v[136:151]
	v_mfma_f32_32x32x16_bf16 v[168:183], a[76:79], v[76:79], v[168:183]
	v_mfma_f32_32x32x16_bf16 v[152:167], a[52:55], v[76:79], v[152:167]
	v_mfma_f32_32x32x16_bf16 v[184:199], v[76:79], v[76:79], v[184:199]
	v_mfma_f32_32x32x16_bf16 v[136:151], a[56:59], v[80:83], v[136:151]
	v_mfma_f32_32x32x16_bf16 v[168:183], a[76:79], v[80:83], v[168:183]
	v_mfma_f32_32x32x16_bf16 v[152:167], a[60:63], v[80:83], v[152:167]
	v_mfma_f32_32x32x16_bf16 v[184:199], v[80:83], v[80:83], v[184:199]
	v_mfma_f32_32x32x16_bf16 v[136:151], a[64:67], v[84:87], v[136:151]
	v_mfma_f32_32x32x16_bf16 v[168:183], a[76:79], v[84:87], v[168:183]
	v_mfma_f32_32x32x16_bf16 v[152:167], a[68:71], v[84:87], v[152:167]
	v_mfma_f32_32x32x16_bf16 v[184:199], v[84:87], v[84:87], v[184:199]
	s_waitcnt vmcnt(8)
	s_waitcnt lgkmcnt(0)
	s_barrier
	v_mfma_f32_32x32x16_bf16 v[136:151], a[8:11], v[88:91], v[136:151]
	ds_read_b128 v[104:107], v248 offset:16384
	ds_read_b128 v[108:111], v249 offset:16384
	ds_read_b128 v[112:115], v250 offset:16384
	s_add_u32 m0, s43, 16384
	ds_read_b128 v[116:119], v251 offset:16384
	ds_read_b64_tr_b16 a[40:41], v12 offset:40960
	v_mfma_f32_32x32x16_bf16 v[168:183], a[76:79], v[88:91], v[168:183]
	ds_read_b64_tr_b16 a[42:43], v12 offset:41472
	ds_read_b64_tr_b16 a[44:45], v13 offset:40960
	ds_read_b64_tr_b16 a[46:47], v13 offset:41472
	ds_read_b64_tr_b16 a[48:49], v14 offset:40960
	s_add_u32 s47, s94, 128
	ds_read_b64_tr_b16 a[50:51], v14 offset:41472
	v_mfma_f32_32x32x16_bf16 v[152:167], a[12:15], v[88:91], v[152:167]
	ds_read_b64_tr_b16 a[52:53], v15 offset:40960
	ds_read_b64_tr_b16 a[54:55], v15 offset:41472
	ds_read_b64_tr_b16 a[56:57], v16 offset:40960
	ds_read_b64_tr_b16 a[58:59], v16 offset:41472
	ds_read_b64_tr_b16 a[60:61], v17 offset:40960
	ds_read_b64_tr_b16 a[62:63], v17 offset:41472
	v_mfma_f32_32x32x16_bf16 v[184:199], v[88:91], v[88:91], v[184:199]
	ds_read_b64_tr_b16 a[64:65], v18 offset:40960
	ds_read_b64_tr_b16 a[66:67], v18 offset:41472
	ds_read_b64_tr_b16 a[68:69], v19 offset:40960
	buffer_load_dwordx4 v6, s[8:11], s47 offen offset:0 lds
	ds_read_b64_tr_b16 a[70:71], v19 offset:41472
	v_mfma_f32_16x16x32_bf16 a[0:3], a[8:11], a[72:75], a[0:3]
	v_mfma_f32_16x16x32_bf16 a[4:7], a[12:15], a[72:75], a[4:7]
	buffer_load_dwordx4 v7, s[8:11], s47 offen offset:1024 lds
	v_mfma_f32_32x32x16_bf16 v[136:151], a[16:19], v[92:95], v[136:151]
	v_mfma_f32_32x32x16_bf16 v[168:183], a[76:79], v[92:95], v[168:183]
	v_mfma_f32_32x32x16_bf16 v[152:167], a[20:23], v[92:95], v[152:167]
	v_mfma_f32_32x32x16_bf16 v[184:199], v[92:95], v[92:95], v[184:199]
	v_mfma_f32_32x32x16_bf16 v[136:151], a[24:27], v[96:99], v[136:151]
	v_mfma_f32_32x32x16_bf16 v[168:183], a[76:79], v[96:99], v[168:183]
	s_add_u32 m0, s43, 24576
	v_mfma_f32_32x32x16_bf16 v[152:167], a[28:31], v[96:99], v[152:167]
	v_mfma_f32_32x32x16_bf16 v[184:199], v[96:99], v[96:99], v[184:199]
	v_mfma_f32_32x32x16_bf16 v[136:151], a[32:35], v[100:103], v[136:151]
	v_mfma_f32_32x32x16_bf16 v[168:183], a[76:79], v[100:103], v[168:183]
	s_add_u32 s47, s95, 128
	v_mfma_f32_32x32x16_bf16 v[152:167], a[36:39], v[100:103], v[152:167]
	s_lshl_b32 s57, s3, 2
	s_add_u32 s57, s57, s32
	s_mul_i32 s57, s57, 25088
	s_lshr_b32 s59, s34, 1
	v_lshrrev_b32 v3, 3, v0
	v_and_b32 v4, 7, v0
	v_lshrrev_b32 v5, 1, v3
	v_mfma_f32_32x32x16_bf16 v[184:199], v[100:103], v[100:103], v[184:199]
	s_waitcnt vmcnt(6)
	ds_read_b128 v[120:123], v248 offset:32768
	ds_read_b128 v[124:127], v249 offset:32768
	ds_read_b128 v[128:131], v250 offset:32768
	ds_read_b128 v[132:135], v251 offset:32768
	ds_read_b64_tr_b16 a[8:9], v12 offset:49152
	ds_read_b64_tr_b16 a[10:11], v12 offset:49664
	s_waitcnt lgkmcnt(6)
	v_mfma_f32_32x32x16_bf16 v[136:151], a[40:43], v[104:107], v[136:151]
	ds_read_b64_tr_b16 a[12:13], v13 offset:49152
	s_mul_i32 s59, s59, 896
	ds_read_b64_tr_b16 a[14:15], v13 offset:49664
	ds_read_b64_tr_b16 a[16:17], v14 offset:49152
	ds_read_b64_tr_b16 a[18:19], v14 offset:49664
	s_add_u32 s57, s57, s59
	v_mfma_f32_32x32x16_bf16 v[168:183], a[76:79], v[104:107], v[168:183]
	ds_read_b64_tr_b16 a[20:21], v15 offset:49152
	ds_read_b64_tr_b16 a[22:23], v15 offset:49664
	ds_read_b64_tr_b16 a[24:25], v16 offset:49152
	ds_read_b64_tr_b16 a[26:27], v16 offset:49664
	v_and_b32 v5, 1, v5
	v_mul_u32_u24 v1, 52, v0
	v_mfma_f32_32x32x16_bf16 v[152:167], a[44:47], v[104:107], v[152:167]
	ds_read_b64_tr_b16 a[28:29], v17 offset:49152
	ds_read_b64_tr_b16 a[30:31], v17 offset:49664
	ds_read_b64_tr_b16 a[32:33], v18 offset:49152
	v_lshrrev_b32 v1, 8, v1
	v_lshlrev_b32 v5, 2, v5
	v_mul_u32_u24 v2, 5, v1
	v_mfma_f32_32x32x16_bf16 v[184:199], v[104:107], v[104:107], v[184:199]
	ds_read_b64_tr_b16 a[34:35], v18 offset:49664
	ds_read_b64_tr_b16 a[36:37], v19 offset:49152
	ds_read_b64_tr_b16 a[38:39], v19 offset:49664
	v_sub_u32 v2, v0, v2
	v_xor_b32 v4, v4, v5
	v_mul_u32_u24 v1, 3584, v1
	v_mfma_f32_16x16x32_bf16 a[0:3], a[40:43], a[72:75], a[0:3]
	v_lshlrev_b32 v4, 4, v4
	v_mfma_f32_16x16x32_bf16 a[4:7], a[44:47], a[72:75], a[4:7]
	v_lshl_add_u32 v1, v2, 7, v1
	v_mfma_f32_32x32x16_bf16 v[136:151], a[48:51], v[108:111], v[136:151]
	buffer_load_dwordx4 v6, s[8:11], s47 offen offset:0 lds
	v_add_u32 v2, 1, v2
	v_mul_u32_u24 v3, 896, v3
	v_lshrrev_b32 v2, 2, v2
	v_lshl_add_u32 v1, v2, 7, v1
	v_mfma_f32_32x32x16_bf16 v[168:183], a[76:79], v[108:111], v[168:183]
	v_add_u32 v244, v3, v4
	v_add_u32 v1, 128, v1
	v_mfma_f32_32x32x16_bf16 v[152:167], a[52:55], v[108:111], v[152:167]
	v_add_u32 v245, 6144, v244
	v_mfma_f32_32x32x16_bf16 v[184:199], v[108:111], v[108:111], v[184:199]
	v_mfma_f32_32x32x16_bf16 v[136:151], a[56:59], v[112:115], v[136:151]
	s_mov_b32 exec_lo, 0xffffffff
	s_mov_b32 exec_hi, 0x7
	buffer_load_dword v242, v1, s[8:11], s57 offen
	s_mov_b64 exec, -1
	v_add_u32 v246, 12288, v244
	v_mfma_f32_32x32x16_bf16 v[168:183], a[76:79], v[112:115], v[168:183]
	v_mfma_f32_32x32x16_bf16 v[152:167], a[60:63], v[112:115], v[152:167]
	v_mfma_f32_32x32x16_bf16 v[184:199], v[112:115], v[112:115], v[184:199]
	buffer_load_dwordx4 v7, s[8:11], s47 offen offset:1024 lds
	v_add_u32 v247, 18432, v244
	v_mfma_f32_32x32x16_bf16 v[136:151], a[64:67], v[116:119], v[136:151]
	v_mfma_f32_32x32x16_bf16 v[168:183], a[76:79], v[116:119], v[168:183]
	v_mfma_f32_32x32x16_bf16 v[152:167], a[68:71], v[116:119], v[152:167]
	v_mfma_f32_32x32x16_bf16 v[184:199], v[116:119], v[116:119], v[184:199]
	ds_read_b64_tr_b16 a[40:41], v12 offset:57344
	ds_read_b64_tr_b16 a[42:43], v12 offset:57856
	ds_read_b64_tr_b16 a[44:45], v13 offset:57344
	ds_read_b64_tr_b16 a[46:47], v13 offset:57856
	ds_read_b64_tr_b16 a[48:49], v14 offset:57344
	ds_read_b64_tr_b16 a[50:51], v14 offset:57856
	ds_read_b64_tr_b16 a[52:53], v15 offset:57344
	s_waitcnt lgkmcnt(15)
	v_mfma_f32_32x32x16_bf16 v[168:183], a[76:79], v[120:123], v[168:183]
	ds_read_b64_tr_b16 a[54:55], v15 offset:57856
	ds_read_b64_tr_b16 a[56:57], v16 offset:57344
	ds_read_b64_tr_b16 a[58:59], v16 offset:57856
	ds_read_b64_tr_b16 a[60:61], v17 offset:57344
	ds_read_b64_tr_b16 a[62:63], v17 offset:57856
	ds_read_b64_tr_b16 a[64:65], v18 offset:57344
	v_mfma_f32_32x32x16_bf16 v[184:199], v[120:123], v[120:123], v[184:199]
	ds_read_b64_tr_b16 a[66:67], v18 offset:57856
	ds_read_b64_tr_b16 a[68:69], v19 offset:57344
	ds_read_b64_tr_b16 a[70:71], v19 offset:57856
	v_mfma_f32_32x32x16_bf16 v[168:183], a[76:79], v[124:127], v[168:183]
	v_mfma_f32_32x32x16_bf16 v[184:199], v[124:127], v[124:127], v[184:199]
	v_mfma_f32_32x32x16_bf16 v[168:183], a[76:79], v[128:131], v[168:183]
	v_mfma_f32_32x32x16_bf16 v[184:199], v[128:131], v[128:131], v[184:199]
	v_mfma_f32_32x32x16_bf16 v[168:183], a[76:79], v[132:135], v[168:183]
	v_mfma_f32_32x32x16_bf16 v[184:199], v[132:135], v[132:135], v[184:199]
	s_waitcnt lgkmcnt(15)
	v_mfma_f32_32x32x16_bf16 v[136:151], a[8:11], v[120:123], v[136:151]
	v_mfma_f32_32x32x16_bf16 v[152:167], a[12:15], v[120:123], v[152:167]
	s_nop 7
	v_mul_f32 v202, 0xbb124925, v168
	v_cndmask_b32 v184, v184, v185, s[64:65]
	v_cndmask_b32 v186, v186, v187, s[64:65]
	v_cndmask_b32 v188, v188, v189, s[64:65]
	v_cndmask_b32 v190, v190, v191, s[64:65]
	v_cndmask_b32 v192, v192, v193, s[64:65]
	v_cndmask_b32 v194, v194, v195, s[64:65]
	v_mfma_f32_16x16x32_bf16 a[0:3], a[8:11], a[72:75], a[0:3]
	v_cndmask_b32 v196, v196, v197, s[64:65]
	v_mfma_f32_16x16x32_bf16 a[4:7], a[12:15], a[72:75], a[4:7]
	v_cndmask_b32 v198, v198, v199, s[64:65]
	v_mfma_f32_32x32x16_bf16 v[136:151], a[16:19], v[124:127], v[136:151]
	v_cndmask_b32 v184, v184, v186, s[66:67]
	v_cndmask_b32 v188, v188, v190, s[66:67]
	v_cndmask_b32 v192, v192, v194, s[66:67]
	v_cndmask_b32 v196, v196, v198, s[66:67]
	v_cndmask_b32 v184, v184, v188, s[68:69]
	v_cndmask_b32 v192, v192, v196, s[68:69]
	v_mfma_f32_32x32x16_bf16 v[152:167], a[20:23], v[124:127], v[152:167]
	s_mov_b64 exec, s[60:61]
	ds_write_b128 v200, a[0:3] offset:0
	ds_write_b128 v200, a[4:7] offset:128
	s_mov_b64 exec, -1
	v_mfma_f32_32x32x16_bf16 v[136:151], a[24:27], v[128:131], v[136:151]
	s_mov_b32 vcc_lo, 0xf0f0f0f0
	v_cndmask_b32 v184, v184, v192, s[70:71]
	v_mov_b32 v203, v184
	v_mfma_f32_32x32x16_bf16 v[152:167], a[28:31], v[128:131], v[152:167]
	s_mov_b32 vcc_hi, 0xf0f0f0f0
	v_permlane32_swap_b32 v203, v184
	v_mul_f32 v228, v202, v202
	v_cndmask_b32 v203, v203, v184, vcc
	v_mul_f32 v203, 0x3b124925, v203
	v_sub_f32 v203, v203, v228
	v_mfma_f32_32x32x16_bf16 v[136:151], a[32:35], v[132:135], v[136:151]
	v_max_f32 v203, 0, v203
	v_add_f32 v203, 0x3727c5ac, v203
	v_rsq_f32 v205, v203
	s_nop 0
	v_mul_f32 v204, v203, v205
	v_mul_f32 v205, 0x3fb8aa3b, v205
	v_mfma_f32_32x32x16_bf16 v[152:167], a[36:39], v[132:135], v[152:167]
	v_cvt_pk_bf16_f32 v228, v202, v204
	v_lshlrev_b32 v229, 16, v228
	v_and_b32 v230, 0xffff0000, v228
	v_sub_f32 v229, v202, v229
	v_sub_f32 v230, v204, v230
	v_cvt_pk_bf16_f32 v208, v202, v229
	v_mov_b32 v209, v228
	v_mov_b32 v211, 0
	v_cvt_pk_bf16_f32 v210, v230, v211
	v_cmp_gt_u32 vcc, 32, v0
	s_nop 1
	v_cndmask_b32 v208, v211, v208, vcc
	v_cndmask_b32 v209, v211, v209, vcc
	v_cndmask_b32 v210, v211, v210, vcc
	v_mov_b32 v215, 0
	v_mov_b32 v219, 0
	s_waitcnt vmcnt(5)
	s_waitcnt lgkmcnt(0)
	s_barrier
	v_mfma_f32_32x32x16_bf16 v[168:183], a[40:43], v[24:27], 0
	ds_read_b32 v224, v201 offset:0
	s_add_u32 m0, s43, 32768
	ds_read_b64_tr_b16 a[8:9], v12 offset:0
	ds_read_b32 v225, v201 offset:256
	s_add_u32 s47, s96, 128
	ds_read_b32 v226, v201 offset:512
	ds_read_b64_tr_b16 a[10:11], v12 offset:512
	ds_read_b32 v227, v201 offset:768
	ds_read_b32 v220, v201 offset:128
	v_mfma_f32_32x32x16_bf16 v[184:199], a[44:47], v[24:27], 0
	buffer_load_dwordx4 v6, s[8:11], s47 offen offset:0 lds
	ds_read_b64_tr_b16 a[12:13], v13 offset:0
	ds_read_b32 v221, v201 offset:384
	ds_read_b32 v222, v201 offset:640
	ds_read_b32 v223, v201 offset:896
	ds_read_b64_tr_b16 a[14:15], v13 offset:512
	v_mfma_f32_16x16x32_bf16 a[0:3], a[40:43], a[72:75], 0
	buffer_load_dwordx4 v7, s[8:11], s47 offen offset:1024 lds
	v_mfma_f32_16x16x32_bf16 a[4:7], a[44:47], a[72:75], 0
	ds_read_u16 v8, v10 offset:0
	ds_read_u16 v9, v10 offset:64
	v_mfma_f32_32x32x16_bf16 v[168:183], a[48:51], v[28:31], v[168:183]
	ds_read_b64_tr_b16 a[16:17], v14 offset:0
	s_add_u32 m0, s43, 40960
	ds_read_b64_tr_b16 a[18:19], v14 offset:512
	s_add_u32 s47, s97, 128
	ds_read_b64_tr_b16 a[20:21], v15 offset:0
	s_waitcnt lgkmcnt(14)
	v_add_f32 v224, v224, v225
	s_waitcnt lgkmcnt(11)
	v_add_f32 v226, v226, v227
	s_waitcnt lgkmcnt(8)
	v_add_f32 v220, v220, v221
	s_waitcnt lgkmcnt(6)
	v_add_f32 v222, v222, v223
	v_mfma_f32_32x32x16_bf16 v[184:199], a[52:55], v[28:31], v[184:199]
	buffer_load_dwordx4 v6, s[8:11], s47 offen offset:0 lds
	ds_read_b64_tr_b16 a[22:23], v15 offset:512
	v_add_f32 v224, v224, v226
	v_add_f32 v220, v220, v222
	v_cvt_pk_bf16_f32 v212, v224, v224
	v_cvt_pk_bf16_f32 v216, v220, v220
	v_mfma_f32_32x32x16_bf16 v[168:183], a[56:59], v[32:35], v[168:183]
	buffer_load_dwordx4 v7, s[8:11], s47 offen offset:1024 lds
	ds_read_b64_tr_b16 a[24:25], v16 offset:0
	s_add_u32 m0, s43, 49152
	ds_read_b64_tr_b16 a[26:27], v16 offset:512
	v_and_b32 v225, 0xffff0000, v212
	v_and_b32 v221, 0xffff0000, v216
	v_sub_f32 v225, v224, v225
	v_sub_f32 v221, v220, v221
	v_mfma_f32_32x32x16_bf16 v[184:199], a[60:63], v[32:35], v[184:199]
	s_add_u32 s47, s91, 256
	ds_read_b64_tr_b16 a[28:29], v17 offset:0
	buffer_load_dwordx4 v6, s[8:11], s47 offen offset:0 lds
	ds_read_b64_tr_b16 a[30:31], v17 offset:512
	s_waitcnt lgkmcnt(9)
	v_lshlrev_b32 v8, 16, v8
	s_waitcnt lgkmcnt(8)
	v_lshlrev_b32 v9, 16, v9
	v_cvt_pk_bf16_f32 v213, v225, v8
	v_cvt_pk_bf16_f32 v214, v8, v215
	v_cvt_pk_bf16_f32 v217, v221, v9
	v_cvt_pk_bf16_f32 v218, v9, v219
	v_mfma_f32_32x32x16_bf16 v[136:151], v[212:215], v[208:211], v[136:151]
	ds_read_b64_tr_b16 a[32:33], v18 offset:0
	buffer_load_dwordx4 v7, s[8:11], s47 offen offset:1024 lds
	ds_read_b64_tr_b16 a[34:35], v18 offset:512
	v_and_b32 v3, 15, v0
	v_lshrrev_b32 v3, 2, v3
	v_mfma_f32_32x32x16_bf16 v[152:167], v[216:219], v[208:211], v[152:167]
	s_mul_i32 s82, s72, 0
	ds_read_b64_tr_b16 a[36:37], v19 offset:0
	s_add_u32 m0, s80, 0
	ds_read_b64_tr_b16 a[38:39], v19 offset:512
	s_add_u32 s82, s82, s73
	buffer_load_dwordx4 v244, s[16:19], s82 offen offset:0 lds
	v_lshrrev_b32 v4, 5, v0
	v_lshl_add_u32 v4, v4, 2, v3
	v_mfma_f32_32x32x16_bf16 v[168:183], a[64:67], v[36:39], v[168:183]
	buffer_load_dwordx4 v245, s[16:19], s82 offen offset:1024 lds
	buffer_load_dwordx4 v246, s[16:19], s82 offen offset:2048 lds
	v_lshlrev_b32 v4, 7, v4
	v_lshrrev_b32 v3, 1, v3
	v_lshl_or_b32 v4, v3, 6, v4
	v_lshrrev_b32 v3, 4, v0
	v_mfma_f32_32x32x16_bf16 v[184:199], a[68:71], v[36:39], v[184:199]
	ds_read_b64_tr_b16 a[40:41], v12 offset:8192
	ds_read_b64_tr_b16 a[42:43], v12 offset:8704
	ds_read_b64_tr_b16 a[44:45], v13 offset:8192
	v_mul_f32 v232, v136, v205
	v_mul_f32 v233, v137, v205
	v_mul_f32 v234, v138, v205
	v_mul_f32 v235, v139, v205
	v_exp_f32 v236, v232
	s_waitcnt lgkmcnt(3)
	v_mfma_f32_32x32x16_bf16 v[168:183], a[8:11], v[40:43], v[168:183]
	buffer_load_dwordx4 v247, s[16:19], s82 offen offset:3072 lds
	ds_read_b64_tr_b16 a[46:47], v13 offset:8704
	ds_read_b64_tr_b16 a[48:49], v14 offset:8192
	v_exp_f32 v237, v233
	v_exp_f32 v238, v234
	v_and_b32 v3, 1, v3
	v_mfma_f32_32x32x16_bf16 v[184:199], a[12:15], v[40:43], v[184:199]
	s_mul_i32 s82, s72, 0
	ds_read_b64_tr_b16 a[50:51], v14 offset:8704
	v_exp_f32 v239, v235
	v_fma_f32 v136, v236, 0.5, 1.0
	v_fma_f32 v137, v237, 0.5, 1.0
	v_lshl_or_b32 v4, v3, 5, v4
	v_fma_f32 v138, v238, 0.5, 1.0
	v_mfma_f32_16x16x32_bf16 a[0:3], a[8:11], a[72:75], a[0:3]
	ds_read_b64_tr_b16 a[52:53], v15 offset:8192
	s_add_u32 m0, s80, 16384
	v_mfma_f32_16x16x32_bf16 a[4:7], a[12:15], a[72:75], a[4:7]
	v_fma_f32 v139, v239, 0.5, 1.0
	v_fma_f32 v236, v236, v136, 1.0
	v_mfma_f32_32x32x16_bf16 v[168:183], a[16:19], v[44:47], v[168:183]
	ds_read_b64_tr_b16 a[54:55], v15 offset:8704
	s_add_u32 s82, s82, s74
	ds_read_b64_tr_b16 a[56:57], v16 offset:8192
	v_fma_f32 v237, v237, v137, 1.0
	v_and_b32 v3, 3, v0
	v_fma_f32 v238, v238, v138, 1.0
	v_fma_f32 v239, v239, v139, 1.0
	v_rcp_f32 v236, v236
	v_mfma_f32_32x32x16_bf16 v[184:199], a[20:23], v[44:47], v[184:199]
	ds_read_b64_tr_b16 a[58:59], v16 offset:8704
	buffer_load_dwordx4 v244, s[16:19], s82 offen offset:0 lds
	ds_read_b64_tr_b16 a[60:61], v17 offset:8192
	v_lshl_or_b32 v4, v3, 3, v4
	v_rcp_f32 v237, v237
	v_mfma_f32_32x32x16_bf16 v[168:183], a[24:27], v[48:51], v[168:183]
	ds_read_b64_tr_b16 a[62:63], v17 offset:8704
	buffer_load_dwordx4 v245, s[16:19], s82 offen offset:1024 lds
	ds_read_b64_tr_b16 a[64:65], v18 offset:8192
	v_rcp_f32 v238, v238
	v_add_u32 v248, s80, v4
	v_rcp_f32 v239, v239
	v_mfma_f32_32x32x16_bf16 v[184:199], a[28:31], v[48:51], v[184:199]
	ds_read_b64_tr_b16 a[66:67], v18 offset:8704
	ds_read_b64_tr_b16 a[68:69], v19 offset:8192
	v_fma_f32 v136, -v232, v236, v232
	v_fma_f32 v137, -v233, v237, v233
	v_fma_f32 v138, -v234, v238, v234
	v_xor_b32 v4, 64, v4
	v_fma_f32 v139, -v235, v239, v235
	v_cvt_pk_bf16_f32 v136, v136, v137
	v_cvt_pk_bf16_f32 v137, v138, v139
	v_mfma_f32_32x32x16_bf16 v[168:183], a[32:35], v[52:55], v[168:183]
	buffer_load_dwordx4 v246, s[16:19], s82 offen offset:2048 lds
	ds_read_b64_tr_b16 a[70:71], v19 offset:8704
	v_mul_f32 v232, v140, v205
	v_add_u32 v249, s80, v4
	v_mul_f32 v233, v141, v205
	v_mul_f32 v234, v142, v205
	v_mul_f32 v235, v143, v205
	v_mfma_f32_32x32x16_bf16 v[184:199], a[36:39], v[52:55], v[184:199]
	buffer_load_dwordx4 v247, s[16:19], s82 offen offset:3072 lds
	v_exp_f32 v236, v232
	v_exp_f32 v237, v233
	v_exp_f32 v238, v234
	v_exp_f32 v239, v235
	v_fma_f32 v140, v236, 0.5, 1.0
	v_fma_f32 v141, v237, 0.5, 1.0
	s_waitcnt vmcnt(14)
	s_waitcnt lgkmcnt(0)
	s_barrier
	v_mfma_f32_32x32x16_bf16 v[168:183], a[40:43], v[56:59], v[168:183]
	ds_read_b64_tr_b16 a[8:9], v12 offset:16384
	s_add_u32 m0, s43, 57344
	ds_read_b64_tr_b16 a[10:11], v12 offset:16896
	s_add_u32 s47, s92, 256
	v_fma_f32 v142, v238, 0.5, 1.0
	v_fma_f32 v143, v239, 0.5, 1.0
	v_fma_f32 v236, v236, v140, 1.0
	v_fma_f32 v237, v237, v141, 1.0
	v_fma_f32 v238, v238, v142, 1.0
	v_fma_f32 v239, v239, v143, 1.0
	v_mfma_f32_32x32x16_bf16 v[184:199], a[44:47], v[56:59], v[184:199]
	ds_read_b64_tr_b16 a[12:13], v13 offset:16384
	ds_read_b64_tr_b16 a[14:15], v13 offset:16896
	buffer_load_dwordx4 v6, s[8:11], s47 offen offset:0 lds
	ds_read_b64_tr_b16 a[16:17], v14 offset:16384
	v_rcp_f32 v236, v236
	v_rcp_f32 v237, v237
	v_mfma_f32_16x16x32_bf16 a[0:3], a[40:43], a[72:75], a[0:3]
	v_rcp_f32 v238, v238
	v_mfma_f32_16x16x32_bf16 a[4:7], a[44:47], a[72:75], a[4:7]
	ds_read_b64_tr_b16 a[18:19], v14 offset:16896
	v_mfma_f32_32x32x16_bf16 v[168:183], a[48:51], v[60:63], v[168:183]
	buffer_load_dwordx4 v7, s[8:11], s47 offen offset:1024 lds
	ds_read_b64_tr_b16 a[20:21], v15 offset:16384
	ds_read_b64_tr_b16 a[22:23], v15 offset:16896
	v_rcp_f32 v239, v239
	v_fma_f32 v140, -v232, v236, v232
	v_fma_f32 v141, -v233, v237, v233
	v_fma_f32 v142, -v234, v238, v234
	v_fma_f32 v143, -v235, v239, v235
	v_mfma_f32_32x32x16_bf16 v[184:199], a[52:55], v[60:63], v[184:199]
	s_add_u32 m0, s43, 0
	ds_read_b64_tr_b16 a[24:25], v16 offset:16384
	s_add_u32 s55, s53, 0
	s_add_u32 s47, s93, 256
	ds_read_b64_tr_b16 a[26:27], v16 offset:16896
	ds_read_b64_tr_b16 a[28:29], v17 offset:16384
	v_cvt_pk_bf16_f32 v138, v140, v141
	v_cvt_pk_bf16_f32 v139, v142, v143
	buffer_store_dwordx4 v[136:139], v231, s[12:15], s55 offen sc1
	v_mfma_f32_32x32x16_bf16 v[168:183], a[56:59], v[64:67], v[168:183]
	buffer_load_dwordx4 v6, s[8:11], s47 offen offset:0 lds
	ds_read_b64_tr_b16 a[30:31], v17 offset:16896
	ds_read_b64_tr_b16 a[32:33], v18 offset:16384
	v_mul_f32 v232, v144, v205
	v_mul_f32 v233, v145, v205
	v_mul_f32 v234, v146, v205
	v_mul_f32 v235, v147, v205
	v_mfma_f32_32x32x16_bf16 v[184:199], a[60:63], v[64:67], v[184:199]
	ds_read_b64_tr_b16 a[34:35], v18 offset:16896
	buffer_load_dwordx4 v7, s[8:11], s47 offen offset:1024 lds
	ds_read_b64_tr_b16 a[36:37], v19 offset:16384
	v_exp_f32 v236, v232
	v_exp_f32 v237, v233
	v_exp_f32 v238, v234
	v_mfma_f32_32x32x16_bf16 v[168:183], a[64:67], v[68:71], v[168:183]
	ds_read_b64_tr_b16 a[38:39], v19 offset:16896
	s_mul_i32 s82, s72, 1
	s_add_u32 m0, s80, 32768
	s_add_u32 s82, s82, s75
	v_exp_f32 v239, v235
	v_fma_f32 v144, v236, 0.5, 1.0
	v_fma_f32 v145, v237, 0.5, 1.0
	v_fma_f32 v146, v238, 0.5, 1.0
	v_fma_f32 v147, v239, 0.5, 1.0
	v_mfma_f32_32x32x16_bf16 v[184:199], a[68:71], v[68:71], v[184:199]
	buffer_load_dwordx4 v244, s[16:19], s82 offen offset:0 lds
	v_fma_f32 v236, v236, v144, 1.0
	v_fma_f32 v237, v237, v145, 1.0
	v_fma_f32 v238, v238, v146, 1.0
	v_fma_f32 v239, v239, v147, 1.0
	v_rcp_f32 v236, v236
	s_waitcnt lgkmcnt(0)
	v_mfma_f32_32x32x16_bf16 v[168:183], a[8:11], v[72:75], v[168:183]
	ds_read_b64_tr_b16 a[40:41], v12 offset:24576
	buffer_load_dwordx4 v245, s[16:19], s82 offen offset:1024 lds
	ds_read_b64_tr_b16 a[42:43], v12 offset:25088
	v_rcp_f32 v237, v237
	v_rcp_f32 v238, v238
	v_rcp_f32 v239, v239
	v_mfma_f32_32x32x16_bf16 v[184:199], a[12:15], v[72:75], v[184:199]
	ds_read_b64_tr_b16 a[44:45], v13 offset:24576
	buffer_load_dwordx4 v246, s[16:19], s82 offen offset:2048 lds
	ds_read_b64_tr_b16 a[46:47], v13 offset:25088
	v_fma_f32 v144, -v232, v236, v232
	v_fma_f32 v145, -v233, v237, v233
	v_fma_f32 v146, -v234, v238, v234
	v_fma_f32 v147, -v235, v239, v235
	v_cvt_pk_bf16_f32 v144, v144, v145
	v_cvt_pk_bf16_f32 v145, v146, v147
	v_mfma_f32_16x16x32_bf16 a[0:3], a[8:11], a[72:75], a[0:3]
	ds_read_b64_tr_b16 a[48:49], v14 offset:24576
	v_mfma_f32_16x16x32_bf16 a[4:7], a[12:15], a[72:75], a[4:7]
	v_mul_f32 v232, v148, v205
	v_mul_f32 v233, v149, v205
	v_mfma_f32_32x32x16_bf16 v[168:183], a[16:19], v[76:79], v[168:183]
	buffer_load_dwordx4 v247, s[16:19], s82 offen offset:3072 lds
	ds_read_b64_tr_b16 a[50:51], v14 offset:25088
	ds_read_b64_tr_b16 a[52:53], v15 offset:24576
	s_mul_i32 s82, s72, 1
	ds_read_b64_tr_b16 a[54:55], v15 offset:25088
	v_mul_f32 v234, v150, v205
	v_mul_f32 v235, v151, v205
	v_exp_f32 v236, v232
	v_mfma_f32_32x32x16_bf16 v[184:199], a[20:23], v[76:79], v[184:199]
	s_add_u32 m0, s80, 49152
	ds_read_b64_tr_b16 a[56:57], v16 offset:24576
	s_add_u32 s82, s82, s76
	ds_read_b64_tr_b16 a[58:59], v16 offset:25088
	v_exp_f32 v237, v233
	v_exp_f32 v238, v234
	v_mfma_f32_32x32x16_bf16 v[168:183], a[24:27], v[80:83], v[168:183]
	ds_read_b64_tr_b16 a[60:61], v17 offset:24576
	buffer_load_dwordx4 v244, s[16:19], s82 offen offset:0 lds
	ds_read_b64_tr_b16 a[62:63], v17 offset:25088
	v_exp_f32 v239, v235
	v_fma_f32 v148, v236, 0.5, 1.0
	v_fma_f32 v149, v237, 0.5, 1.0
	v_fma_f32 v150, v238, 0.5, 1.0
	v_fma_f32 v151, v239, 0.5, 1.0
	v_mfma_f32_32x32x16_bf16 v[184:199], a[28:31], v[80:83], v[184:199]
	ds_read_b64_tr_b16 a[64:65], v18 offset:24576
	buffer_load_dwordx4 v245, s[16:19], s82 offen offset:1024 lds
	ds_read_b64_tr_b16 a[66:67], v18 offset:25088
	v_fma_f32 v236, v236, v148, 1.0
	v_fma_f32 v237, v237, v149, 1.0
	v_fma_f32 v238, v238, v150, 1.0
	v_fma_f32 v239, v239, v151, 1.0
	v_rcp_f32 v236, v236
	v_mfma_f32_32x32x16_bf16 v[168:183], a[32:35], v[84:87], v[168:183]
	ds_read_b64_tr_b16 a[68:69], v19 offset:24576
	ds_read_b64_tr_b16 a[70:71], v19 offset:25088
	buffer_load_dwordx4 v246, s[16:19], s82 offen offset:2048 lds
	v_rcp_f32 v237, v237
	v_rcp_f32 v238, v238
	v_mfma_f32_32x32x16_bf16 v[184:199], a[36:39], v[84:87], v[184:199]
	buffer_load_dwordx4 v247, s[16:19], s82 offen offset:3072 lds
	s_add_u32 s55, s53, 2048
	v_rcp_f32 v239, v239
	v_fma_f32 v148, -v232, v236, v232
	v_fma_f32 v149, -v233, v237, v233
	v_fma_f32 v150, -v234, v238, v234
	v_fma_f32 v151, -v235, v239, v235
	v_cvt_pk_bf16_f32 v146, v148, v149
	v_cvt_pk_bf16_f32 v147, v150, v151
	buffer_store_dwordx4 v[144:147], v231, s[12:15], s55 offen sc1
	s_waitcnt vmcnt(22)
	s_waitcnt lgkmcnt(0)
	s_barrier
	v_mfma_f32_32x32x16_bf16 v[168:183], a[40:43], v[88:91], v[168:183]
	s_waitcnt vmcnt(14)
	ds_read_b64_tr_b16 a[8:9], v12 offset:32768
	s_add_u32 m0, s43, 8192
	ds_read_b64_tr_b16 a[80:81], v248 offset:0
	ds_read_b64_tr_b16 a[10:11], v12 offset:33280
	v_mul_f32 v232, v152, v205
	v_mul_f32 v233, v153, v205
	v_mul_f32 v234, v154, v205
	v_mul_f32 v235, v155, v205
	v_exp_f32 v236, v232
	v_mfma_f32_32x32x16_bf16 v[184:199], a[44:47], v[88:91], v[184:199]
	s_add_u32 s47, s94, 256
	ds_read_b64_tr_b16 a[12:13], v13 offset:32768
	ds_read_b64_tr_b16 a[82:83], v248 offset:1024
	ds_read_b64_tr_b16 a[14:15], v13 offset:33280
	ds_read_b64_tr_b16 a[84:85], v249 offset:0
	ds_read_b64_tr_b16 a[16:17], v14 offset:32768
	v_exp_f32 v237, v233
	v_exp_f32 v238, v234
	v_mfma_f32_16x16x32_bf16 a[0:3], a[40:43], a[72:75], a[0:3]
	buffer_load_dwordx4 v6, s[8:11], s47 offen offset:0 lds
	v_mfma_f32_16x16x32_bf16 a[4:7], a[44:47], a[72:75], a[4:7]
	v_exp_f32 v239, v235
	v_mfma_f32_32x32x16_bf16 v[168:183], a[48:51], v[92:95], v[168:183]
	ds_read_b64_tr_b16 a[18:19], v14 offset:33280
	ds_read_b64_tr_b16 a[86:87], v249 offset:1024
	ds_read_b64_tr_b16 a[20:21], v15 offset:32768
	ds_read_b64_tr_b16 a[22:23], v15 offset:33280
	ds_read_b64_tr_b16 a[88:89], v248 offset:2048
	v_fma_f32 v152, v236, 0.5, 1.0
	v_fma_f32 v153, v237, 0.5, 1.0
	v_fma_f32 v154, v238, 0.5, 1.0
	v_fma_f32 v155, v239, 0.5, 1.0
	v_fma_f32 v236, v236, v152, 1.0
	v_mfma_f32_32x32x16_bf16 v[184:199], a[52:55], v[92:95], v[184:199]
	buffer_load_dwordx4 v7, s[8:11], s47 offen offset:1024 lds
	ds_read_b64_tr_b16 a[24:25], v16 offset:32768
	ds_read_b64_tr_b16 a[90:91], v248 offset:3072
	ds_read_b64_tr_b16 a[26:27], v16 offset:33280
	v_fma_f32 v237, v237, v153, 1.0
	v_fma_f32 v238, v238, v154, 1.0
	v_fma_f32 v239, v239, v155, 1.0
	v_rcp_f32 v236, v236
	v_mfma_f32_32x32x16_bf16 v[168:183], a[56:59], v[96:99], v[168:183]
	s_add_u32 m0, s43, 16384
	ds_read_b64_tr_b16 a[28:29], v17 offset:32768
	ds_read_b64_tr_b16 a[92:93], v249 offset:2048
	ds_read_b64_tr_b16 a[30:31], v17 offset:33280
	s_add_u32 s47, s95, 256
	v_rcp_f32 v237, v237
	v_rcp_f32 v238, v238
	v_mfma_f32_32x32x16_bf16 v[184:199], a[60:63], v[96:99], v[184:199]
	ds_read_b64_tr_b16 a[94:95], v249 offset:3072
	ds_read_b64_tr_b16 a[32:33], v18 offset:32768
	ds_read_b64_tr_b16 a[34:35], v18 offset:33280
	ds_read_b64_tr_b16 a[96:97], v248 offset:16384
	v_rcp_f32 v239, v239
	v_fma_f32 v152, -v232, v236, v232
	v_fma_f32 v153, -v233, v237, v233
	v_fma_f32 v154, -v234, v238, v234
	v_fma_f32 v155, -v235, v239, v235
	v_mfma_f32_32x32x16_bf16 v[168:183], a[64:67], v[100:103], v[168:183]
	buffer_load_dwordx4 v6, s[8:11], s47 offen offset:0 lds
	ds_read_b64_tr_b16 a[36:37], v19 offset:32768
	ds_read_b64_tr_b16 a[98:99], v248 offset:17408
	ds_read_b64_tr_b16 a[38:39], v19 offset:33280
	v_cvt_pk_bf16_f32 v152, v152, v153
	v_cvt_pk_bf16_f32 v153, v154, v155
	v_mul_f32 v232, v156, v205
	v_mul_f32 v233, v157, v205
	v_mul_f32 v234, v158, v205
	v_mfma_f32_32x32x16_bf16 v[184:199], a[68:71], v[100:103], v[184:199]
	ds_read_b64_tr_b16 a[100:101], v249 offset:16384
	buffer_load_dwordx4 v7, s[8:11], s47 offen offset:1024 lds
	ds_read_b64_tr_b16 a[102:103], v249 offset:17408
	v_mul_f32 v235, v159, v205
	v_exp_f32 v236, v232
	v_exp_f32 v237, v233
	s_waitcnt lgkmcnt(2)
	v_mfma_f32_32x32x16_bf16 v[168:183], a[8:11], v[104:107], v[168:183]
	ds_read_b64_tr_b16 a[104:105], v248 offset:18432
	buffer_load_dword v243, off, s[20:23], 0
	ds_read_b64_tr_b16 a[106:107], v248 offset:19456
	v_exp_f32 v238, v234
	v_exp_f32 v239, v235
	v_fma_f32 v156, v236, 0.5, 1.0
	v_fma_f32 v157, v237, 0.5, 1.0
	v_mfma_f32_32x32x16_bf16 v[184:199], a[12:15], v[104:107], v[184:199]
	ds_read_b64_tr_b16 a[40:41], v12 offset:40960
	ds_read_b64_tr_b16 a[42:43], v12 offset:41472
	ds_read_b64_tr_b16 a[108:109], v249 offset:18432
	ds_read_b64_tr_b16 a[44:45], v13 offset:40960
	v_fma_f32 v158, v238, 0.5, 1.0
	v_fma_f32 v159, v239, 0.5, 1.0
	v_fma_f32 v236, v236, v156, 1.0
	v_fma_f32 v237, v237, v157, 1.0
	v_fma_f32 v238, v238, v158, 1.0
	v_fma_f32 v239, v239, v159, 1.0
	v_mfma_f32_16x16x32_bf16 a[0:3], a[8:11], a[72:75], a[0:3]
	v_rcp_f32 v236, v236
	v_mfma_f32_16x16x32_bf16 a[4:7], a[12:15], a[72:75], a[4:7]
	ds_read_b64_tr_b16 a[46:47], v13 offset:41472
	ds_read_b64_tr_b16 a[110:111], v249 offset:19456
	v_mfma_f32_32x32x16_bf16 v[168:183], a[16:19], v[108:111], v[168:183]
	ds_read_b64_tr_b16 a[48:49], v14 offset:40960
	ds_read_b64_tr_b16 a[50:51], v14 offset:41472
	ds_read_b64_tr_b16 a[52:53], v15 offset:40960
	v_rcp_f32 v237, v237
	v_rcp_f32 v238, v238
	v_rcp_f32 v239, v239
	v_fma_f32 v156, -v232, v236, v232
	v_mfma_f32_32x32x16_bf16 v[184:199], a[20:23], v[108:111], v[184:199]
	s_mul_i32 s82, s72, 2
	s_add_u32 m0, s80, 0
	ds_read_b64_tr_b16 a[54:55], v15 offset:41472
	ds_read_b64_tr_b16 a[56:57], v16 offset:40960
	s_add_u32 s82, s82, s73
	v_fma_f32 v157, -v233, v237, v233
	v_fma_f32 v158, -v234, v238, v234
	v_fma_f32 v159, -v235, v239, v235
	v_cvt_pk_bf16_f32 v154, v156, v157
	v_cvt_pk_bf16_f32 v155, v158, v159
	v_mfma_f32_32x32x16_bf16 v[168:183], a[24:27], v[112:115], v[168:183]
	ds_read_b64_tr_b16 a[58:59], v16 offset:41472
	s_add_u32 s55, s53, 4096
	buffer_store_dwordx4 v[152:155], v231, s[12:15], s55 offen sc1
	ds_read_b64_tr_b16 a[60:61], v17 offset:40960
	buffer_load_dwordx4 v244, s[16:19], s82 offen offset:0 lds
	ds_read_b64_tr_b16 a[62:63], v17 offset:41472
	v_mul_f32 v232, v160, v205
	v_mul_f32 v233, v161, v205
	v_mfma_f32_32x32x16_bf16 v[184:199], a[28:31], v[112:115], v[184:199]
	ds_read_b64_tr_b16 a[64:65], v18 offset:40960
	ds_read_b64_tr_b16 a[66:67], v18 offset:41472
	buffer_load_dwordx4 v245, s[16:19], s82 offen offset:1024 lds
	v_mul_f32 v234, v162, v205
	v_mul_f32 v235, v163, v205
	v_exp_f32 v236, v232
	v_exp_f32 v237, v233
	v_mfma_f32_32x32x16_bf16 v[168:183], a[32:35], v[116:119], v[168:183]
	ds_read_b64_tr_b16 a[68:69], v19 offset:40960
	ds_read_b64_tr_b16 a[70:71], v19 offset:41472
	v_exp_f32 v238, v234
	v_exp_f32 v239, v235
	v_fma_f32 v160, v236, 0.5, 1.0
	v_fma_f32 v161, v237, 0.5, 1.0
	v_fma_f32 v162, v238, 0.5, 1.0
	v_mfma_f32_32x32x16_bf16 v[184:199], a[36:39], v[116:119], v[184:199]
	buffer_load_dwordx4 v246, s[16:19], s82 offen offset:2048 lds
	v_fma_f32 v163, v239, 0.5, 1.0
	v_fma_f32 v236, v236, v160, 1.0
	v_fma_f32 v237, v237, v161, 1.0
	v_fma_f32 v238, v238, v162, 1.0
	v_fma_f32 v239, v239, v163, 1.0
	v_rcp_f32 v236, v236
	s_waitcnt lgkmcnt(0)
	v_mfma_f32_32x32x16_bf16 v[168:183], a[40:43], v[120:123], v[168:183]
	buffer_load_dwordx4 v247, s[16:19], s82 offen offset:3072 lds
	ds_read_b64_tr_b16 a[8:9], v12 offset:49152
	ds_read_b64_tr_b16 a[10:11], v12 offset:49664
	v_rcp_f32 v237, v237
	v_rcp_f32 v238, v238
	v_rcp_f32 v239, v239
	v_mfma_f32_32x32x16_bf16 v[184:199], a[44:47], v[120:123], v[184:199]
	s_mul_i32 s82, s72, 2
	ds_read_b64_tr_b16 a[12:13], v13 offset:49152
	s_add_u32 m0, s80, 16384
	ds_read_b64_tr_b16 a[14:15], v13 offset:49664
	v_fma_f32 v160, -v232, v236, v232
	v_fma_f32 v161, -v233, v237, v233
	v_fma_f32 v162, -v234, v238, v234
	v_fma_f32 v163, -v235, v239, v235
	v_cvt_pk_bf16_f32 v160, v160, v161
	v_cvt_pk_bf16_f32 v161, v162, v163
	v_mfma_f32_16x16x32_bf16 a[0:3], a[40:43], a[72:75], a[0:3]
	ds_read_b64_tr_b16 a[16:17], v14 offset:49152
	s_add_u32 s82, s82, s74
	v_mfma_f32_16x16x32_bf16 a[4:7], a[44:47], a[72:75], a[4:7]
	v_mul_f32 v232, v164, v205
	v_mul_f32 v233, v165, v205
	v_mfma_f32_32x32x16_bf16 v[168:183], a[48:51], v[124:127], v[168:183]
	ds_read_b64_tr_b16 a[18:19], v14 offset:49664
	ds_read_b64_tr_b16 a[20:21], v15 offset:49152
	buffer_load_dwordx4 v244, s[16:19], s82 offen offset:0 lds
	ds_read_b64_tr_b16 a[22:23], v15 offset:49664
	v_mul_f32 v234, v166, v205
	v_mul_f32 v235, v167, v205
	v_exp_f32 v236, v232
	v_mfma_f32_32x32x16_bf16 v[184:199], a[52:55], v[124:127], v[184:199]
	ds_read_b64_tr_b16 a[24:25], v16 offset:49152
	ds_read_b64_tr_b16 a[26:27], v16 offset:49664
	buffer_load_dwordx4 v245, s[16:19], s82 offen offset:1024 lds
	v_exp_f32 v237, v233
	v_exp_f32 v238, v234
	v_exp_f32 v239, v235
	v_mfma_f32_32x32x16_bf16 v[168:183], a[56:59], v[128:131], v[168:183]
	ds_read_b64_tr_b16 a[28:29], v17 offset:49152
	ds_read_b64_tr_b16 a[30:31], v17 offset:49664
	ds_read_b64_tr_b16 a[32:33], v18 offset:49152
	v_fma_f32 v164, v236, 0.5, 1.0
	v_fma_f32 v165, v237, 0.5, 1.0
	v_fma_f32 v166, v238, 0.5, 1.0
	v_fma_f32 v167, v239, 0.5, 1.0
	v_fma_f32 v236, v236, v164, 1.0
	v_fma_f32 v237, v237, v165, 1.0
	v_fma_f32 v238, v238, v166, 1.0
	v_mfma_f32_32x32x16_bf16 v[184:199], a[60:63], v[128:131], v[184:199]
	buffer_load_dwordx4 v246, s[16:19], s82 offen offset:2048 lds
	ds_read_b64_tr_b16 a[34:35], v18 offset:49664
	ds_read_b64_tr_b16 a[36:37], v19 offset:49152
	v_fma_f32 v239, v239, v167, 1.0
	v_rcp_f32 v236, v236
	v_rcp_f32 v237, v237
	v_mfma_f32_32x32x16_bf16 v[168:183], a[64:67], v[132:135], v[168:183]
	s_mov_b64 exec, s[60:61]
	ds_write_b128 v200, a[0:3] offset:1024
	ds_write_b128 v200, a[4:7] offset:1152
	s_mov_b64 exec, -1
	ds_read_b64_tr_b16 a[38:39], v19 offset:49664
	v_mfma_f32_32x32x16_bf16 v[184:199], a[68:71], v[132:135], v[184:199]
	buffer_load_dwordx4 v247, s[16:19], s82 offen offset:3072 lds
	s_add_u32 s55, s53, 6144
	v_rcp_f32 v238, v238
	v_rcp_f32 v239, v239
	v_fma_f32 v164, -v232, v236, v232
	v_fma_f32 v165, -v233, v237, v233
	v_fma_f32 v166, -v234, v238, v234
	v_fma_f32 v167, -v235, v239, v235
	v_cvt_pk_bf16_f32 v162, v164, v165
	v_cvt_pk_bf16_f32 v163, v166, v167
	buffer_store_dwordx4 v[160:163], v231, s[12:15], s55 offen sc1
	s_waitcnt vmcnt(24)
	s_waitcnt lgkmcnt(0)
	s_barrier
	v_mfma_f32_32x32x16_bf16 v[136:151], a[8:11], v[24:27], 0
	s_waitcnt vmcnt(16)
	ds_read_b32 v224, v201 offset:1024
	s_add_u32 m0, s43, 24576
	ds_read_b64_tr_b16 a[40:41], v12 offset:57344
	ds_read_b32 v225, v201 offset:1280
	ds_read_b64_tr_b16 a[112:113], v248 offset:32768
	s_add_u32 s47, s96, 256
	ds_read_b32 v226, v201 offset:1536
	ds_read_b64_tr_b16 a[42:43], v12 offset:57856
	ds_read_b32 v227, v201 offset:1792
	v_mfma_f32_32x32x16_bf16 v[152:167], a[12:15], v[24:27], 0
	ds_read_b64_tr_b16 a[114:115], v248 offset:33792
	ds_read_b32 v220, v201 offset:1152
	buffer_load_dwordx4 v6, s[8:11], s47 offen offset:0 lds
	ds_read_b64_tr_b16 a[44:45], v13 offset:57344
	ds_read_b32 v221, v201 offset:1408
	ds_read_b64_tr_b16 a[116:117], v249 offset:32768
	ds_read_b32 v222, v201 offset:1664
	v_mfma_f32_16x16x32_bf16 a[0:3], a[8:11], a[72:75], 0
	ds_read_b32 v223, v201 offset:1920
	ds_read_b64_tr_b16 a[46:47], v13 offset:57856
	v_mfma_f32_16x16x32_bf16 a[4:7], a[12:15], a[72:75], 0
	ds_read_b64_tr_b16 a[118:119], v249 offset:33792
	v_mfma_f32_32x32x16_bf16 v[136:151], a[16:19], v[28:31], v[136:151]
	buffer_load_dwordx4 v7, s[8:11], s47 offen offset:1024 lds
	ds_read_u16 v8, v10 offset:128
	ds_read_u16 v9, v10 offset:192
	ds_read_b64_tr_b16 a[48:49], v14 offset:57344
	ds_read_b64_tr_b16 a[120:121], v248 offset:34816
	s_add_u32 m0, s43, 32768
	s_waitcnt lgkmcnt(15)
	v_add_f32 v224, v224, v225
	s_waitcnt lgkmcnt(13)
	v_add_f32 v226, v226, v227
	v_mfma_f32_32x32x16_bf16 v[152:167], a[20:23], v[28:31], v[152:167]
	ds_read_b64_tr_b16 a[50:51], v14 offset:57856
	ds_read_b64_tr_b16 a[122:123], v248 offset:35840
	s_add_u32 s47, s97, 256
	ds_read_b64_tr_b16 a[124:125], v249 offset:34816
	ds_read_b64_tr_b16 a[52:53], v15 offset:57344
	s_waitcnt lgkmcnt(13)
	v_add_f32 v220, v220, v221
	s_waitcnt lgkmcnt(10)
	v_add_f32 v222, v222, v223
	v_add_f32 v224, v224, v226
	v_mfma_f32_32x32x16_bf16 v[136:151], a[24:27], v[32:35], v[136:151]
	buffer_load_dwordx4 v6, s[8:11], s47 offen offset:0 lds
	ds_read_b64_tr_b16 a[126:127], v249 offset:35840
	ds_read_b64_tr_b16 a[54:55], v15 offset:57856
	buffer_load_dwordx4 v7, s[8:11], s47 offen offset:1024 lds
	v_add_f32 v220, v220, v222
	v_cvt_pk_bf16_f32 v212, v224, v224
	v_cvt_pk_bf16_f32 v216, v220, v220
	v_mfma_f32_32x32x16_bf16 v[152:167], a[28:31], v[32:35], v[152:167]
	ds_read_b64_tr_b16 a[128:129], v248 offset:49152
	ds_read_b64_tr_b16 a[56:57], v16 offset:57344
	ds_read_b64_tr_b16 a[130:131], v248 offset:50176
	s_add_u32 m0, s43, 40960
	ds_read_b64_tr_b16 a[58:59], v16 offset:57856
	v_and_b32 v225, 0xffff0000, v212
	v_and_b32 v221, 0xffff0000, v216
	v_sub_f32 v225, v224, v225
	v_sub_f32 v221, v220, v221
	s_waitcnt lgkmcnt(13)
	v_lshlrev_b32 v8, 16, v8
	s_waitcnt lgkmcnt(12)
	v_lshlrev_b32 v9, 16, v9
	v_cvt_pk_bf16_f32 v213, v225, v8
	v_cvt_pk_bf16_f32 v214, v8, v215
	v_cvt_pk_bf16_f32 v217, v221, v9
	v_cvt_pk_bf16_f32 v218, v9, v219
	v_mfma_f32_32x32x16_bf16 v[168:183], v[212:215], v[208:211], v[168:183]
	s_add_u32 s47, s91, s58
	ds_read_b64_tr_b16 a[132:133], v249 offset:49152
	ds_read_b64_tr_b16 a[60:61], v17 offset:57344
	v_mfma_f32_32x32x16_bf16 v[184:199], v[216:219], v[208:211], v[184:199]
	ds_read_b64_tr_b16 a[134:135], v249 offset:50176
	buffer_load_dwordx4 v6, s[8:11], s47 offen offset:0 lds
	ds_read_b64_tr_b16 a[62:63], v17 offset:57856
	ds_read_b64_tr_b16 a[136:137], v248 offset:51200
	ds_read_b64_tr_b16 a[64:65], v18 offset:57344
	buffer_load_dwordx4 v7, s[8:11], s47 offen offset:1024 lds
	v_mfma_f32_32x32x16_bf16 v[136:151], a[32:35], v[36:39], v[136:151]
	ds_read_b64_tr_b16 a[138:139], v248 offset:52224
	ds_read_b64_tr_b16 a[66:67], v18 offset:57856
	ds_read_b64_tr_b16 a[140:141], v249 offset:51200
	ds_read_b64_tr_b16 a[68:69], v19 offset:57344
	ds_read_b64_tr_b16 a[142:143], v249 offset:52224
	ds_read_b64_tr_b16 a[70:71], v19 offset:57856
	s_mul_i32 s82, s72, 3
	s_add_u32 m0, s80, 32768
	s_add_u32 s82, s82, s75
	v_mfma_f32_32x32x16_bf16 v[152:167], a[36:39], v[36:39], v[152:167]
	s_waitcnt lgkmcnt(15)
	buffer_load_dwordx4 v244, s[16:19], s82 offen offset:0 lds
	buffer_load_dwordx4 v245, s[16:19], s82 offen offset:1024 lds
	ds_read_b64_tr_b16 a[8:9], v12 offset:0
	ds_read_b64_tr_b16 a[10:11], v12 offset:512
	v_mul_f32 v232, v168, v205
	v_mul_f32 v233, v169, v205
	v_mul_f32 v234, v170, v205
	s_waitcnt lgkmcnt(2)
	v_mfma_f32_32x32x16_bf16 v[136:151], a[40:43], v[40:43], v[136:151]
	ds_read_b64_tr_b16 a[12:13], v13 offset:0
	buffer_load_dwordx4 v246, s[16:19], s82 offen offset:2048 lds
	v_mul_f32 v235, v171, v205
	v_exp_f32 v236, v232
	v_exp_f32 v237, v233
	v_mfma_f32_32x32x16_bf16 v[152:167], a[44:47], v[40:43], v[152:167]
	ds_read_b64_tr_b16 a[14:15], v13 offset:512
	ds_read_b64_tr_b16 a[16:17], v14 offset:0
	buffer_load_dwordx4 v247, s[16:19], s82 offen offset:3072 lds
	ds_read_b64_tr_b16 a[18:19], v14 offset:512
	v_exp_f32 v238, v234
	v_exp_f32 v239, v235
	v_mfma_f32_16x16x32_bf16 a[0:3], a[40:43], a[72:75], a[0:3]
	v_fma_f32 v168, v236, 0.5, 1.0
	v_fma_f32 v169, v237, 0.5, 1.0
	v_mfma_f32_16x16x32_bf16 a[4:7], a[44:47], a[72:75], a[4:7]
	ds_read_b64_tr_b16 a[20:21], v15 offset:0
	v_fma_f32 v170, v238, 0.5, 1.0
	v_mfma_f32_32x32x16_bf16 v[136:151], a[48:51], v[44:47], v[136:151]
	s_mul_i32 s82, s72, 3
	ds_read_b64_tr_b16 a[22:23], v15 offset:512
	s_add_u32 m0, s80, 49152
	ds_read_b64_tr_b16 a[24:25], v16 offset:0
	v_fma_f32 v171, v239, 0.5, 1.0
	v_fma_f32 v236, v236, v168, 1.0
	v_fma_f32 v237, v237, v169, 1.0
	v_fma_f32 v238, v238, v170, 1.0
	v_fma_f32 v239, v239, v171, 1.0
	v_mfma_f32_32x32x16_bf16 v[152:167], a[52:55], v[44:47], v[152:167]
	s_add_u32 s82, s82, s76
	ds_read_b64_tr_b16 a[26:27], v16 offset:512
	ds_read_b64_tr_b16 a[28:29], v17 offset:0
	v_rcp_f32 v236, v236
	v_rcp_f32 v237, v237
	v_mfma_f32_32x32x16_bf16 v[136:151], a[56:59], v[48:51], v[136:151]
	buffer_load_dwordx4 v244, s[16:19], s82 offen offset:0 lds
	ds_read_b64_tr_b16 a[30:31], v17 offset:512
	ds_read_b64_tr_b16 a[32:33], v18 offset:0
	v_rcp_f32 v238, v238
	v_rcp_f32 v239, v239
	v_fma_f32 v168, -v232, v236, v232
	v_mfma_f32_32x32x16_bf16 v[152:167], a[60:63], v[48:51], v[152:167]
	buffer_load_dwordx4 v245, s[16:19], s82 offen offset:1024 lds
	ds_read_b64_tr_b16 a[34:35], v18 offset:512
	ds_read_b64_tr_b16 a[36:37], v19 offset:0
	v_fma_f32 v169, -v233, v237, v233
	v_fma_f32 v170, -v234, v238, v234
	v_fma_f32 v171, -v235, v239, v235
	v_cvt_pk_bf16_f32 v168, v168, v169
	v_cvt_pk_bf16_f32 v169, v170, v171
	v_mfma_f32_32x32x16_bf16 v[136:151], a[64:67], v[52:55], v[136:151]
	buffer_load_dwordx4 v246, s[16:19], s82 offen offset:2048 lds
	ds_read_b64_tr_b16 a[38:39], v19 offset:512
	v_mul_f32 v232, v172, v205
	v_mul_f32 v233, v173, v205
	v_mul_f32 v234, v174, v205
	v_mul_f32 v235, v175, v205
	v_exp_f32 v236, v232
	v_mfma_f32_32x32x16_bf16 v[152:167], a[68:71], v[52:55], v[152:167]
	buffer_load_dwordx4 v247, s[16:19], s82 offen offset:3072 lds
	v_exp_f32 v237, v233
	v_exp_f32 v238, v234
	v_exp_f32 v239, v235
	v_fma_f32 v172, v236, 0.5, 1.0
	v_fma_f32 v173, v237, 0.5, 1.0
	s_waitcnt vmcnt(25)
	s_waitcnt lgkmcnt(0)
	s_barrier
	v_mfma_f32_32x32x16_bf16 v[136:151], a[8:11], v[56:59], v[136:151]
	s_waitcnt vmcnt(15)
	ds_read_b64_tr_b16 a[40:41], v12 offset:8192
	s_add_u32 m0, s43, 49152
	ds_read_b64_tr_b16 a[144:145], v248 offset:0
	ds_read_b64_tr_b16 a[42:43], v12 offset:8704
	ds_read_b64_tr_b16 a[146:147], v248 offset:1024
	s_add_u32 s47, s92, s58
	v_fma_f32 v174, v238, 0.5, 1.0
	v_fma_f32 v175, v239, 0.5, 1.0
	v_fma_f32 v236, v236, v172, 1.0
	v_fma_f32 v237, v237, v173, 1.0
	v_mfma_f32_32x32x16_bf16 v[152:167], a[12:15], v[56:59], v[152:167]
	ds_read_b64_tr_b16 a[44:45], v13 offset:8192
	ds_read_b64_tr_b16 a[148:149], v249 offset:0
	ds_read_b64_tr_b16 a[46:47], v13 offset:8704
	buffer_load_dwordx4 v6, s[8:11], s47 offen offset:0 lds
	ds_read_b64_tr_b16 a[150:151], v249 offset:1024
	v_fma_f32 v238, v238, v174, 1.0
	v_fma_f32 v239, v239, v175, 1.0
	v_rcp_f32 v236, v236
	v_mfma_f32_16x16x32_bf16 a[0:3], a[8:11], a[72:75], a[0:3]
	v_rcp_f32 v237, v237
	v_mfma_f32_16x16x32_bf16 a[4:7], a[12:15], a[72:75], a[4:7]
	ds_read_b64_tr_b16 a[48:49], v14 offset:8192
	v_mfma_f32_32x32x16_bf16 v[136:151], a[16:19], v[60:63], v[136:151]
	ds_read_b64_tr_b16 a[152:153], v248 offset:2048
	ds_read_b64_tr_b16 a[50:51], v14 offset:8704
	ds_read_b64_tr_b16 a[154:155], v248 offset:3072
	buffer_load_dwordx4 v7, s[8:11], s47 offen offset:1024 lds
	ds_read_b64_tr_b16 a[52:53], v15 offset:8192
	v_rcp_f32 v238, v238
	v_rcp_f32 v239, v239
	v_fma_f32 v172, -v232, v236, v232
	v_mfma_f32_32x32x16_bf16 v[152:167], a[20:23], v[60:63], v[152:167]
	ds_read_b64_tr_b16 a[156:157], v249 offset:2048
	ds_read_b64_tr_b16 a[54:55], v15 offset:8704
	s_add_u32 m0, s43, 57344
	ds_read_b64_tr_b16 a[158:159], v249 offset:3072
	ds_read_b64_tr_b16 a[56:57], v16 offset:8192
	v_fma_f32 v173, -v233, v237, v233
	v_fma_f32 v174, -v234, v238, v234
	v_fma_f32 v175, -v235, v239, v235
	v_cvt_pk_bf16_f32 v170, v172, v173
	v_cvt_pk_bf16_f32 v171, v174, v175
	v_mfma_f32_32x32x16_bf16 v[136:151], a[24:27], v[64:67], v[136:151]
	ds_read_b64_tr_b16 a[160:161], v248 offset:16384
	s_add_u32 s55, s53, 8192
	s_add_u32 s47, s93, s58
	ds_read_b64_tr_b16 a[58:59], v16 offset:8704
	buffer_store_dwordx4 v[168:171], v231, s[12:15], s55 offen sc1
	ds_read_b64_tr_b16 a[162:163], v248 offset:17408
	ds_read_b64_tr_b16 a[60:61], v17 offset:8192
	v_mul_f32 v232, v176, v205
	v_mul_f32 v233, v177, v205
	v_mfma_f32_32x32x16_bf16 v[152:167], a[28:31], v[64:67], v[152:167]
	buffer_load_dwordx4 v6, s[8:11], s47 offen offset:0 lds
	ds_read_b64_tr_b16 a[164:165], v249 offset:16384
	ds_read_b64_tr_b16 a[62:63], v17 offset:8704
	ds_read_b64_tr_b16 a[166:167], v249 offset:17408
	ds_read_b64_tr_b16 a[64:65], v18 offset:8192
	ds_read_b64_tr_b16 a[168:169], v248 offset:18432
	v_mul_f32 v234, v178, v205
	v_mul_f32 v235, v179, v205
	v_exp_f32 v236, v232
	v_mfma_f32_32x32x16_bf16 v[136:151], a[32:35], v[68:71], v[136:151]
	ds_read_b64_tr_b16 a[66:67], v18 offset:8704
	buffer_load_dwordx4 v7, s[8:11], s47 offen offset:1024 lds
	ds_read_b64_tr_b16 a[170:171], v248 offset:19456
	ds_read_b64_tr_b16 a[68:69], v19 offset:8192
	v_exp_f32 v237, v233
	v_exp_f32 v238, v234
	v_mfma_f32_32x32x16_bf16 v[152:167], a[36:39], v[68:71], v[152:167]
	ds_read_b64_tr_b16 a[70:71], v19 offset:8704
	ds_read_b64_tr_b16 a[172:173], v249 offset:18432
	ds_read_b64_tr_b16 a[174:175], v249 offset:19456
	s_mul_i32 s82, s72, 4
	v_exp_f32 v239, v235
	v_fma_f32 v176, v236, 0.5, 1.0
	v_fma_f32 v177, v237, 0.5, 1.0
	v_fma_f32 v178, v238, 0.5, 1.0
	v_fma_f32 v179, v239, 0.5, 1.0
	v_fma_f32 v236, v236, v176, 1.0
	s_waitcnt lgkmcnt(2)
	v_mfma_f32_32x32x16_bf16 v[136:151], a[40:43], v[72:75], v[136:151]
	s_add_u32 m0, s80, 0
	s_add_u32 s82, s82, s73
	v_fma_f32 v237, v237, v177, 1.0
	v_fma_f32 v238, v238, v178, 1.0
	v_fma_f32 v239, v239, v179, 1.0
	v_rcp_f32 v236, v236
	v_rcp_f32 v237, v237
	v_mfma_f32_32x32x16_bf16 v[152:167], a[44:47], v[72:75], v[152:167]
	buffer_load_dwordx4 v244, s[16:19], s82 offen offset:0 lds
	ds_read_b64_tr_b16 a[8:9], v12 offset:16384
	ds_read_b64_tr_b16 a[10:11], v12 offset:16896
	buffer_load_dwordx4 v245, s[16:19], s82 offen offset:1024 lds
	v_rcp_f32 v238, v238
	v_rcp_f32 v239, v239
	v_fma_f32 v176, -v232, v236, v232
	v_mfma_f32_16x16x32_bf16 a[0:3], a[40:43], a[72:75], a[0:3]
	ds_read_b64_tr_b16 a[12:13], v13 offset:16384
	v_fma_f32 v177, -v233, v237, v233
	v_mfma_f32_16x16x32_bf16 a[4:7], a[44:47], a[72:75], a[4:7]
	v_fma_f32 v178, -v234, v238, v234
	v_fma_f32 v179, -v235, v239, v235
	v_mfma_f32_32x32x16_bf16 v[136:151], a[48:51], v[76:79], v[136:151]
	ds_read_b64_tr_b16 a[14:15], v13 offset:16896
	buffer_load_dwordx4 v246, s[16:19], s82 offen offset:2048 lds
	ds_read_b64_tr_b16 a[16:17], v14 offset:16384
	ds_read_b64_tr_b16 a[18:19], v14 offset:16896
	v_cvt_pk_bf16_f32 v176, v176, v177
	v_cvt_pk_bf16_f32 v177, v178, v179
	v_mul_f32 v232, v180, v205
	v_mul_f32 v233, v181, v205
	v_mul_f32 v234, v182, v205
	v_mul_f32 v235, v183, v205
	v_mfma_f32_32x32x16_bf16 v[152:167], a[52:55], v[76:79], v[152:167]
	ds_read_b64_tr_b16 a[20:21], v15 offset:16384
	buffer_load_dwordx4 v247, s[16:19], s82 offen offset:3072 lds
	ds_read_b64_tr_b16 a[22:23], v15 offset:16896
	s_mul_i32 s82, s72, 4
	ds_read_b64_tr_b16 a[24:25], v16 offset:16384
	v_exp_f32 v236, v232
	v_exp_f32 v237, v233
	v_mfma_f32_32x32x16_bf16 v[136:151], a[56:59], v[80:83], v[136:151]
	s_add_u32 m0, s80, 16384
	ds_read_b64_tr_b16 a[26:27], v16 offset:16896
	s_add_u32 s82, s82, s74
	ds_read_b64_tr_b16 a[28:29], v17 offset:16384
	v_exp_f32 v238, v234
	v_exp_f32 v239, v235
	v_fma_f32 v180, v236, 0.5, 1.0
	v_fma_f32 v181, v237, 0.5, 1.0
	v_fma_f32 v182, v238, 0.5, 1.0
	v_mfma_f32_32x32x16_bf16 v[152:167], a[60:63], v[80:83], v[152:167]
	ds_read_b64_tr_b16 a[30:31], v17 offset:16896
	s_waitcnt lgkmcnt(12)
	buffer_load_dwordx4 v244, s[16:19], s82 offen offset:0 lds
	ds_read_b64_tr_b16 a[32:33], v18 offset:16384
	ds_read_b64_tr_b16 a[34:35], v18 offset:16896
	v_fma_f32 v183, v239, 0.5, 1.0
	v_fma_f32 v236, v236, v180, 1.0
	v_fma_f32 v237, v237, v181, 1.0
	v_fma_f32 v238, v238, v182, 1.0
	v_fma_f32 v239, v239, v183, 1.0
	v_mfma_f32_32x32x16_bf16 v[136:151], a[64:67], v[84:87], v[136:151]
	buffer_load_dwordx4 v245, s[16:19], s82 offen offset:1024 lds
	ds_read_b64_tr_b16 a[36:37], v19 offset:16384
	ds_read_b64_tr_b16 a[38:39], v19 offset:16896
	v_rcp_f32 v236, v236
	v_rcp_f32 v237, v237
	v_rcp_f32 v238, v238
	v_mfma_f32_32x32x16_bf16 v[152:167], a[68:71], v[84:87], v[152:167]
	buffer_load_dwordx4 v246, s[16:19], s82 offen offset:2048 lds
	buffer_load_dwordx4 v247, s[16:19], s82 offen offset:3072 lds
	s_add_u32 s55, s53, 10240
	v_rcp_f32 v239, v239
	v_fma_f32 v180, -v232, v236, v232
	v_fma_f32 v181, -v233, v237, v233
	v_fma_f32 v182, -v234, v238, v234
	v_fma_f32 v183, -v235, v239, v235
	v_cvt_pk_bf16_f32 v178, v180, v181
	v_cvt_pk_bf16_f32 v179, v182, v183
	buffer_store_dwordx4 v[176:179], v231, s[12:15], s55 offen sc1
	s_waitcnt vmcnt(22)
	s_waitcnt lgkmcnt(0)
	s_barrier
	v_mfma_f32_32x32x16_bf16 v[136:151], a[8:11], v[88:91], v[136:151]
	s_waitcnt vmcnt(14)
	ds_read_b64_tr_b16 a[40:41], v12 offset:24576
	s_add_u32 m0, s43, 0
	ds_read_b64_tr_b16 a[176:177], v248 offset:32768
	ds_read_b64_tr_b16 a[42:43], v12 offset:25088
	v_mul_f32 v232, v184, v205
	v_mul_f32 v233, v185, v205
	v_mul_f32 v234, v186, v205
	v_mul_f32 v235, v187, v205
	v_exp_f32 v236, v232
	v_mfma_f32_32x32x16_bf16 v[152:167], a[12:15], v[88:91], v[152:167]
	ds_read_b64_tr_b16 a[44:45], v13 offset:24576
	ds_read_b64_tr_b16 a[178:179], v248 offset:33792
	s_add_u32 s47, s94, s58
	ds_read_b64_tr_b16 a[46:47], v13 offset:25088
	ds_read_b64_tr_b16 a[180:181], v249 offset:32768
	v_exp_f32 v237, v233
	v_exp_f32 v238, v234
	v_mfma_f32_16x16x32_bf16 a[0:3], a[8:11], a[72:75], a[0:3]
	ds_read_b64_tr_b16 a[48:49], v14 offset:24576
	v_mfma_f32_16x16x32_bf16 a[4:7], a[12:15], a[72:75], a[4:7]
	v_exp_f32 v239, v235
	v_mfma_f32_32x32x16_bf16 v[136:151], a[16:19], v[92:95], v[136:151]
	ds_read_b64_tr_b16 a[50:51], v14 offset:25088
	buffer_load_dwordx4 v6, s[8:11], s47 offen offset:0 lds
	ds_read_b64_tr_b16 a[182:183], v249 offset:33792
	ds_read_b64_tr_b16 a[52:53], v15 offset:24576
	v_fma_f32 v184, v236, 0.5, 1.0
	v_fma_f32 v185, v237, 0.5, 1.0
	v_fma_f32 v186, v238, 0.5, 1.0
	v_fma_f32 v187, v239, 0.5, 1.0
	v_fma_f32 v236, v236, v184, 1.0
	v_mfma_f32_32x32x16_bf16 v[152:167], a[20:23], v[92:95], v[152:167]
	ds_read_b64_tr_b16 a[54:55], v15 offset:25088
	ds_read_b64_tr_b16 a[184:185], v248 offset:34816
	ds_read_b64_tr_b16 a[56:57], v16 offset:24576
	ds_read_b64_tr_b16 a[186:187], v248 offset:35840
	buffer_load_dwordx4 v7, s[8:11], s47 offen offset:1024 lds
	v_fma_f32 v237, v237, v185, 1.0
	v_fma_f32 v238, v238, v186, 1.0
	v_fma_f32 v239, v239, v187, 1.0
	v_mfma_f32_32x32x16_bf16 v[136:151], a[24:27], v[96:99], v[136:151]
	ds_read_b64_tr_b16 a[58:59], v16 offset:25088
	ds_read_b64_tr_b16 a[60:61], v17 offset:24576
	ds_read_b64_tr_b16 a[188:189], v249 offset:34816
	ds_read_b64_tr_b16 a[62:63], v17 offset:25088
	v_rcp_f32 v236, v236
	v_rcp_f32 v237, v237
	v_rcp_f32 v238, v238
	v_mfma_f32_32x32x16_bf16 v[152:167], a[28:31], v[96:99], v[152:167]
	s_add_u32 m0, s43, 8192
	ds_read_b64_tr_b16 a[190:191], v249 offset:35840
	ds_read_b64_tr_b16 a[64:65], v18 offset:24576
	ds_read_b64_tr_b16 a[66:67], v18 offset:25088
	ds_read_b64_tr_b16 a[192:193], v248 offset:49152
	v_rcp_f32 v239, v239
	v_fma_f32 v184, -v232, v236, v232
	v_fma_f32 v185, -v233, v237, v233
	v_fma_f32 v186, -v234, v238, v234
	v_mfma_f32_32x32x16_bf16 v[136:151], a[32:35], v[100:103], v[136:151]
	s_add_u32 s47, s95, s58
	ds_read_b64_tr_b16 a[68:69], v19 offset:24576
	ds_read_b64_tr_b16 a[194:195], v248 offset:50176
	ds_read_b64_tr_b16 a[70:71], v19 offset:25088
	v_fma_f32 v187, -v235, v239, v235
	v_cvt_pk_bf16_f32 v184, v184, v185
	v_cvt_pk_bf16_f32 v185, v186, v187
	v_mul_f32 v232, v188, v205
	v_mul_f32 v233, v189, v205
	v_mul_f32 v234, v190, v205
	v_mfma_f32_32x32x16_bf16 v[152:167], a[36:39], v[100:103], v[152:167]
	buffer_load_dwordx4 v6, s[8:11], s47 offen offset:0 lds
	ds_read_b64_tr_b16 a[196:197], v249 offset:49152
	ds_read_b64_tr_b16 a[198:199], v249 offset:50176
	v_mul_f32 v235, v191, v205
	v_exp_f32 v236, v232
	v_exp_f32 v237, v233
	s_waitcnt lgkmcnt(2)
	v_mfma_f32_32x32x16_bf16 v[136:151], a[40:43], v[104:107], v[136:151]
	ds_read_b64_tr_b16 a[200:201], v248 offset:51200
	buffer_load_dwordx4 v7, s[8:11], s47 offen offset:1024 lds
	ds_read_b64_tr_b16 a[202:203], v248 offset:52224
	v_exp_f32 v238, v234
	v_exp_f32 v239, v235
	v_fma_f32 v188, v236, 0.5, 1.0
	v_fma_f32 v189, v237, 0.5, 1.0
	v_mfma_f32_32x32x16_bf16 v[152:167], a[44:47], v[104:107], v[152:167]
	ds_read_b64_tr_b16 a[8:9], v12 offset:32768
	ds_read_b64_tr_b16 a[10:11], v12 offset:33280
	ds_read_b64_tr_b16 a[204:205], v249 offset:51200
	ds_read_b64_tr_b16 a[12:13], v13 offset:32768
	v_fma_f32 v190, v238, 0.5, 1.0
	v_fma_f32 v191, v239, 0.5, 1.0
	v_fma_f32 v236, v236, v188, 1.0
	v_fma_f32 v237, v237, v189, 1.0
	v_fma_f32 v238, v238, v190, 1.0
	v_fma_f32 v239, v239, v191, 1.0
	v_mfma_f32_16x16x32_bf16 a[0:3], a[40:43], a[72:75], a[0:3]
	v_rcp_f32 v236, v236
	v_mfma_f32_16x16x32_bf16 a[4:7], a[44:47], a[72:75], a[4:7]
	ds_read_b64_tr_b16 a[14:15], v13 offset:33280
	ds_read_b64_tr_b16 a[206:207], v249 offset:52224
	v_mfma_f32_32x32x16_bf16 v[136:151], a[48:51], v[108:111], v[136:151]
	ds_read_b64_tr_b16 a[16:17], v14 offset:32768
	ds_read_b64_tr_b16 a[18:19], v14 offset:33280
	ds_read_b64_tr_b16 a[20:21], v15 offset:32768
	v_rcp_f32 v237, v237
	v_rcp_f32 v238, v238
	v_rcp_f32 v239, v239
	v_mfma_f32_32x32x16_bf16 v[152:167], a[52:55], v[108:111], v[152:167]
	s_mul_i32 s82, s72, 5
	s_add_u32 m0, s80, 32768
	ds_read_b64_tr_b16 a[22:23], v15 offset:33280
	ds_read_b64_tr_b16 a[24:25], v16 offset:32768
	s_add_u32 s82, s82, s75
	v_fma_f32 v188, -v232, v236, v232
	v_fma_f32 v189, -v233, v237, v233
	v_fma_f32 v190, -v234, v238, v234
	v_fma_f32 v191, -v235, v239, v235
	v_cvt_pk_bf16_f32 v186, v188, v189
	v_mfma_f32_32x32x16_bf16 v[136:151], a[56:59], v[112:115], v[136:151]
	ds_read_b64_tr_b16 a[26:27], v16 offset:33280
	s_add_u32 s55, s53, 12288
	ds_read_b64_tr_b16 a[28:29], v17 offset:32768
	buffer_load_dwordx4 v244, s[16:19], s82 offen offset:0 lds
	v_cvt_pk_bf16_f32 v187, v190, v191
	buffer_store_dwordx4 v[184:187], v231, s[12:15], s55 offen sc1
	v_mul_f32 v232, v192, v205
	v_mul_f32 v233, v193, v205
	v_mfma_f32_32x32x16_bf16 v[152:167], a[60:63], v[112:115], v[152:167]
	ds_read_b64_tr_b16 a[30:31], v17 offset:33280
	ds_read_b64_tr_b16 a[32:33], v18 offset:32768
	ds_read_b64_tr_b16 a[34:35], v18 offset:33280
	v_mul_f32 v234, v194, v205
	v_mul_f32 v235, v195, v205
	v_exp_f32 v236, v232
	v_exp_f32 v237, v233
	v_mfma_f32_32x32x16_bf16 v[136:151], a[64:67], v[116:119], v[136:151]
	buffer_load_dwordx4 v245, s[16:19], s82 offen offset:1024 lds
	ds_read_b64_tr_b16 a[36:37], v19 offset:32768
	ds_read_b64_tr_b16 a[38:39], v19 offset:33280
	v_exp_f32 v238, v234
	v_exp_f32 v239, v235
	v_fma_f32 v192, v236, 0.5, 1.0
	v_fma_f32 v193, v237, 0.5, 1.0
	v_mfma_f32_32x32x16_bf16 v[152:167], a[68:71], v[116:119], v[152:167]
	buffer_load_dwordx4 v246, s[16:19], s82 offen offset:2048 lds
	v_fma_f32 v194, v238, 0.5, 1.0
	v_fma_f32 v195, v239, 0.5, 1.0
	v_fma_f32 v236, v236, v192, 1.0
	v_fma_f32 v237, v237, v193, 1.0
	v_fma_f32 v238, v238, v194, 1.0
	v_fma_f32 v239, v239, v195, 1.0
	v_rcp_f32 v236, v236
	s_waitcnt lgkmcnt(0)
	v_mfma_f32_32x32x16_bf16 v[136:151], a[8:11], v[120:123], v[136:151]
	buffer_load_dwordx4 v247, s[16:19], s82 offen offset:3072 lds
	s_lshl_b32 s49, s48, 6
	s_mul_i32 s82, s72, 5
	v_rcp_f32 v237, v237
	v_rcp_f32 v238, v238
	v_rcp_f32 v239, v239
	v_mfma_f32_32x32x16_bf16 v[152:167], a[12:15], v[120:123], v[152:167]
	s_add_u32 m0, s80, 49152
	v_xor_b32 v12, s49, v12
	v_fma_f32 v192, -v232, v236, v232
	v_fma_f32 v193, -v233, v237, v233
	v_xor_b32 v14, s49, v14
	v_fma_f32 v194, -v234, v238, v234
	v_fma_f32 v195, -v235, v239, v235
	v_cvt_pk_bf16_f32 v192, v192, v193
	v_xor_b32 v16, s49, v16
	v_mfma_f32_16x16x32_bf16 a[0:3], a[8:11], a[72:75], a[0:3]
	s_add_u32 s82, s82, s76
	v_cvt_pk_bf16_f32 v193, v194, v195
	v_mfma_f32_16x16x32_bf16 a[4:7], a[12:15], a[72:75], a[4:7]
	v_mul_f32 v232, v196, v205
	v_mul_f32 v233, v197, v205
	v_mfma_f32_32x32x16_bf16 v[136:151], a[16:19], v[124:127], v[136:151]
	ds_read_b64_tr_b16 a[40:41], v12 offset:40960
	buffer_load_dwordx4 v244, s[16:19], s82 offen offset:0 lds
	v_xor_b32 v18, s49, v18
	v_mul_f32 v234, v198, v205
	v_mul_f32 v235, v199, v205
	v_exp_f32 v236, v232
	v_exp_f32 v237, v233
	v_mfma_f32_32x32x16_bf16 v[152:167], a[20:23], v[124:127], v[152:167]
	ds_read_b64_tr_b16 a[42:43], v12 offset:41472
	ds_read_b64_tr_b16 a[48:49], v14 offset:40960
	buffer_load_dwordx4 v245, s[16:19], s82 offen offset:1024 lds
	ds_read_b64_tr_b16 a[50:51], v14 offset:41472
	v_exp_f32 v238, v234
	v_exp_f32 v239, v235
	v_fma_f32 v196, v236, 0.5, 1.0
	v_mfma_f32_32x32x16_bf16 v[136:151], a[24:27], v[128:131], v[136:151]
	ds_read_b64_tr_b16 a[56:57], v16 offset:40960
	ds_read_b64_tr_b16 a[58:59], v16 offset:41472
	v_fma_f32 v197, v237, 0.5, 1.0
	v_fma_f32 v198, v238, 0.5, 1.0
	v_fma_f32 v199, v239, 0.5, 1.0
	v_fma_f32 v236, v236, v196, 1.0
	v_fma_f32 v237, v237, v197, 1.0
	v_fma_f32 v238, v238, v198, 1.0
	v_mfma_f32_32x32x16_bf16 v[152:167], a[28:31], v[128:131], v[152:167]
	buffer_load_dwordx4 v246, s[16:19], s82 offen offset:2048 lds
	ds_read_b64_tr_b16 a[64:65], v18 offset:40960
	ds_read_b64_tr_b16 a[66:67], v18 offset:41472
	v_fma_f32 v239, v239, v199, 1.0
	v_rcp_f32 v236, v236
	v_rcp_f32 v237, v237
	v_mfma_f32_32x32x16_bf16 v[136:151], a[32:35], v[132:135], v[136:151]
	s_mov_b64 exec, s[60:61]
	ds_write_b128 v200, a[0:3] offset:0
	ds_write_b128 v200, a[4:7] offset:128
	s_mov_b64 exec, -1
	v_rcp_f32 v238, v238
	v_mfma_f32_32x32x16_bf16 v[152:167], a[36:39], v[132:135], v[152:167]
	buffer_load_dwordx4 v247, s[16:19], s82 offen offset:3072 lds
	s_add_u32 s55, s53, 14336
	v_rcp_f32 v239, v239
	v_fma_f32 v196, -v232, v236, v232
	v_fma_f32 v197, -v233, v237, v233
	v_fma_f32 v198, -v234, v238, v234
	v_fma_f32 v199, -v235, v239, v235
	v_cvt_pk_bf16_f32 v194, v196, v197
	v_cvt_pk_bf16_f32 v195, v198, v199
	buffer_store_dwordx4 v[192:195], v231, s[12:15], s55 offen sc1
	s_waitcnt vmcnt(23)
	s_waitcnt lgkmcnt(0)
	s_barrier
	v_mfma_f32_32x32x16_bf16 v[168:183], a[40:43], v[24:27], 0
	s_waitcnt vmcnt(15)
	ds_read_b32 v224, v201 offset:0
	s_add_u32 m0, s43, 136192
	ds_read_b64_tr_b16 a[208:209], v248 offset:0
	ds_read_b32 v225, v201 offset:256
	ds_read_b64_tr_b16 a[8:9], v12 offset:49152
	ds_read_b32 v226, v201 offset:512
	ds_read_b64_tr_b16 a[210:211], v248 offset:1024
	s_add_u32 s47, s96, s58
	ds_read_b32 v227, v201 offset:768
	ds_read_b32 v220, v201 offset:128
	ds_read_b64_tr_b16 a[212:213], v249 offset:0
	ds_read_b32 v221, v201 offset:384
	ds_read_b32 v222, v201 offset:640
	ds_read_b64_tr_b16 a[10:11], v12 offset:49664
	buffer_load_dwordx4 v6, s[8:11], s47 offen offset:0 lds
	ds_read_b64_tr_b16 a[214:215], v249 offset:1024
	ds_read_b32 v223, v201 offset:896
	ds_read_u16 v8, v10 offset:256
	v_mfma_f32_16x16x32_bf16 a[0:3], a[40:43], a[72:75], 0
	ds_read_b64_tr_b16 a[216:217], v248 offset:2048
	ds_read_u16 v9, v10 offset:320
	s_waitcnt lgkmcnt(14)
	v_add_f32 v224, v224, v225
	v_mfma_f32_32x32x16_bf16 v[168:183], a[48:51], v[28:31], v[168:183]
	ds_read_b64_tr_b16 a[16:17], v14 offset:49152
	ds_read_b64_tr_b16 a[218:219], v248 offset:3072
	buffer_load_dwordx4 v7, s[8:11], s47 offen offset:1024 lds
	ds_read_b64_tr_b16 a[220:221], v249 offset:2048
	s_add_u32 m0, s43, 144384
	ds_read_b64_tr_b16 a[222:223], v249 offset:3072
	ds_read_b64_tr_b16 a[18:19], v14 offset:49664
	ds_read_b64_tr_b16 a[224:225], v248 offset:16384
	s_add_u32 s47, s97, s58
	ds_read_b64_tr_b16 a[226:227], v248 offset:17408
	s_waitcnt lgkmcnt(15)
	v_add_f32 v226, v226, v227
	s_waitcnt lgkmcnt(14)
	v_add_f32 v220, v220, v221
	s_waitcnt lgkmcnt(10)
	v_add_f32 v222, v222, v223
	v_add_f32 v224, v224, v226
	v_add_f32 v220, v220, v222
	v_cvt_pk_bf16_f32 v212, v224, v224
	v_cvt_pk_bf16_f32 v216, v220, v220
	v_and_b32 v225, 0xffff0000, v212
	v_mfma_f32_32x32x16_bf16 v[168:183], a[56:59], v[32:35], v[168:183]
	ds_read_b64_tr_b16 a[24:25], v16 offset:49152
	buffer_load_dwordx4 v6, s[8:11], s47 offen offset:0 lds
	ds_read_b64_tr_b16 a[228:229], v249 offset:16384
	ds_read_b64_tr_b16 a[230:231], v249 offset:17408
	ds_read_b64_tr_b16 a[26:27], v16 offset:49664
	ds_read_b64_tr_b16 a[232:233], v248 offset:18432
	buffer_load_dwordx4 v7, s[8:11], s47 offen offset:1024 lds
	ds_read_b64_tr_b16 a[234:235], v248 offset:19456
	v_and_b32 v221, 0xffff0000, v216
	v_sub_f32 v225, v224, v225
	v_sub_f32 v221, v220, v221
	s_waitcnt lgkmcnt(15)
	v_lshlrev_b32 v8, 16, v8
	s_waitcnt lgkmcnt(13)
	v_lshlrev_b32 v9, 16, v9
	v_cvt_pk_bf16_f32 v213, v225, v8
	v_cvt_pk_bf16_f32 v214, v8, v215
	v_cvt_pk_bf16_f32 v217, v221, v9
	v_cvt_pk_bf16_f32 v218, v9, v219
	v_mfma_f32_32x32x16_bf16 v[136:151], v[212:215], v[208:211], v[136:151]
	ds_read_b64_tr_b16 a[32:33], v18 offset:49152
	ds_read_b64_tr_b16 a[236:237], v249 offset:18432
	ds_read_b64_tr_b16 a[238:239], v249 offset:19456
	ds_read_b64_tr_b16 a[34:35], v18 offset:49664
	v_mfma_f32_32x32x16_bf16 v[152:167], v[216:219], v[208:211], v[152:167]
	s_mul_i32 s82, s72, 6
	s_add_u32 m0, s80, 0
	s_add_u32 s82, s82, s73
	s_waitcnt lgkmcnt(13)
	buffer_load_dwordx4 v244, s[16:19], s82 offen offset:0 lds
	buffer_load_dwordx4 v245, s[16:19], s82 offen offset:1024 lds
	buffer_load_dwordx4 v246, s[16:19], s82 offen offset:2048 lds
	buffer_load_dwordx4 v247, s[16:19], s82 offen offset:3072 lds
	s_mul_i32 s82, s72, 6
	s_add_u32 m0, s80, 16384
	s_add_u32 s82, s82, s74
	s_waitcnt lgkmcnt(1)
	buffer_load_dwordx4 v244, s[16:19], s82 offen offset:0 lds
	v_mfma_f32_32x32x16_bf16 v[168:183], a[64:67], v[36:39], v[168:183]
	ds_read_b64_tr_b16 a[40:41], v12 offset:57344
	ds_read_b64_tr_b16 a[42:43], v12 offset:57856
	v_mul_f32 v232, v136, v205
	v_mul_f32 v233, v137, v205
	v_mul_f32 v234, v138, v205
	v_mul_f32 v235, v139, v205
	v_exp_f32 v236, v232
	v_exp_f32 v237, v233
	v_exp_f32 v238, v234
	v_exp_f32 v239, v235
	v_fma_f32 v136, v236, 0.5, 1.0
	v_fma_f32 v137, v237, 0.5, 1.0
	v_fma_f32 v138, v238, 0.5, 1.0
	v_fma_f32 v139, v239, 0.5, 1.0
	v_fma_f32 v236, v236, v136, 1.0
	s_waitcnt lgkmcnt(2)
	v_mfma_f32_32x32x16_bf16 v[168:183], a[8:11], v[40:43], v[168:183]
	ds_read_b64_tr_b16 a[48:49], v14 offset:57344
	ds_read_b64_tr_b16 a[50:51], v14 offset:57856
	v_fma_f32 v237, v237, v137, 1.0
	v_fma_f32 v238, v238, v138, 1.0
	v_fma_f32 v239, v239, v139, 1.0
	v_rcp_f32 v236, v236
	v_rcp_f32 v237, v237
	v_rcp_f32 v238, v238
	v_rcp_f32 v239, v239
	v_fma_f32 v136, -v232, v236, v232
	v_fma_f32 v137, -v233, v237, v233
	v_fma_f32 v138, -v234, v238, v234
	v_fma_f32 v139, -v235, v239, v235
	v_cvt_pk_bf16_f32 v136, v136, v137
	v_cvt_pk_bf16_f32 v137, v138, v139
	v_mfma_f32_16x16x32_bf16 a[0:3], a[8:11], a[72:75], a[0:3]
	v_mul_f32 v232, v140, v205
	v_mul_f32 v233, v141, v205
	v_mul_f32 v234, v142, v205
	v_mfma_f32_32x32x16_bf16 v[168:183], a[16:19], v[44:47], v[168:183]
	ds_read_b64_tr_b16 a[56:57], v16 offset:57344
	ds_read_b64_tr_b16 a[58:59], v16 offset:57856
	v_mul_f32 v235, v143, v205
	v_exp_f32 v236, v232
	v_exp_f32 v237, v233
	v_exp_f32 v238, v234
	v_exp_f32 v239, v235
	v_fma_f32 v140, v236, 0.5, 1.0
	v_fma_f32 v141, v237, 0.5, 1.0
	v_fma_f32 v142, v238, 0.5, 1.0
	v_fma_f32 v143, v239, 0.5, 1.0
	v_fma_f32 v236, v236, v140, 1.0
	v_fma_f32 v237, v237, v141, 1.0
	v_fma_f32 v238, v238, v142, 1.0
	v_fma_f32 v239, v239, v143, 1.0
	v_mfma_f32_32x32x16_bf16 v[168:183], a[24:27], v[48:51], v[168:183]
	buffer_load_dwordx4 v245, s[16:19], s82 offen offset:1024 lds
	ds_read_b64_tr_b16 a[64:65], v18 offset:57344
	s_add_u32 s55, s53, 16384
	v_rcp_f32 v236, v236
	v_rcp_f32 v237, v237
	v_rcp_f32 v238, v238
	v_rcp_f32 v239, v239
	v_fma_f32 v140, -v232, v236, v232
	v_fma_f32 v141, -v233, v237, v233
	v_fma_f32 v142, -v234, v238, v234
	v_fma_f32 v143, -v235, v239, v235
	v_cvt_pk_bf16_f32 v138, v140, v141
	v_cvt_pk_bf16_f32 v139, v142, v143
	v_mfma_f32_32x32x16_bf16 v[168:183], a[32:35], v[52:55], v[168:183]
	buffer_load_dwordx4 v246, s[16:19], s82 offen offset:2048 lds
	buffer_store_dwordx4 v[136:139], v231, s[12:15], s55 offen sc1
	ds_read_b64_tr_b16 a[66:67], v18 offset:57856
	buffer_load_dwordx4 v247, s[16:19], s82 offen offset:3072 lds
	v_mul_f32 v232, v144, v205
	v_mul_f32 v233, v145, v205
	v_mul_f32 v234, v146, v205
	v_mul_f32 v235, v147, v205
	v_exp_f32 v236, v232
	v_exp_f32 v237, v233
	v_exp_f32 v238, v234
	v_exp_f32 v239, v235
	v_fma_f32 v144, v236, 0.5, 1.0
	v_fma_f32 v145, v237, 0.5, 1.0
	v_fma_f32 v146, v238, 0.5, 1.0
	v_fma_f32 v147, v239, 0.5, 1.0
	v_fma_f32 v236, v236, v144, 1.0
	v_fma_f32 v237, v237, v145, 1.0
	v_fma_f32 v238, v238, v146, 1.0
	v_fma_f32 v239, v239, v147, 1.0
	v_rcp_f32 v236, v236
	v_rcp_f32 v237, v237
	v_rcp_f32 v238, v238
	v_rcp_f32 v239, v239
	v_fma_f32 v144, -v232, v236, v232
	s_waitcnt vmcnt(23)
	s_waitcnt lgkmcnt(0)
	s_barrier
	v_mfma_f32_32x32x16_bf16 v[168:183], a[40:43], v[56:59], v[168:183]
	s_waitcnt vmcnt(18)
	ds_read_b64_tr_b16 a[8:9], v12 offset:0
	ds_read_b64_tr_b16 a[240:241], v248 offset:32768
	ds_read_b64_tr_b16 a[10:11], v12 offset:512
	ds_read_b64_tr_b16 a[242:243], v248 offset:33792
	v_fma_f32 v145, -v233, v237, v233
	v_fma_f32 v146, -v234, v238, v234
	v_fma_f32 v147, -v235, v239, v235
	v_cvt_pk_bf16_f32 v144, v144, v145
	v_cvt_pk_bf16_f32 v145, v146, v147
	v_mul_f32 v232, v148, v205
	v_mul_f32 v233, v149, v205
	v_mul_f32 v234, v150, v205
	v_mul_f32 v235, v151, v205
	v_exp_f32 v236, v232
	v_exp_f32 v237, v233
	v_exp_f32 v238, v234
	v_exp_f32 v239, v235
	v_fma_f32 v148, v236, 0.5, 1.0
	v_fma_f32 v149, v237, 0.5, 1.0
	v_fma_f32 v150, v238, 0.5, 1.0
	v_fma_f32 v151, v239, 0.5, 1.0
	v_fma_f32 v236, v236, v148, 1.0
	v_mfma_f32_16x16x32_bf16 a[0:3], a[40:43], a[72:75], a[0:3]
	ds_read_b64_tr_b16 a[16:17], v14 offset:0
	ds_read_b64_tr_b16 a[244:245], v249 offset:32768
	v_fma_f32 v237, v237, v149, 1.0
	v_fma_f32 v238, v238, v150, 1.0
	v_fma_f32 v239, v239, v151, 1.0
	v_mfma_f32_32x32x16_bf16 v[168:183], a[48:51], v[60:63], v[168:183]
	ds_read_b64_tr_b16 a[18:19], v14 offset:512
	ds_read_b64_tr_b16 a[246:247], v249 offset:33792
	ds_read_b64_tr_b16 a[24:25], v16 offset:0
	s_add_u32 s55, s53, 18432
	ds_read_b64_tr_b16 a[248:249], v248 offset:34816
	v_rcp_f32 v236, v236
	v_rcp_f32 v237, v237
	v_rcp_f32 v238, v238
	v_rcp_f32 v239, v239
	v_fma_f32 v148, -v232, v236, v232
	v_fma_f32 v149, -v233, v237, v233
	v_fma_f32 v150, -v234, v238, v234
	v_fma_f32 v151, -v235, v239, v235
	v_cvt_pk_bf16_f32 v146, v148, v149
	v_cvt_pk_bf16_f32 v147, v150, v151
	buffer_store_dwordx4 v[144:147], v231, s[12:15], s55 offen sc1
	v_mul_f32 v232, v152, v205
	v_mul_f32 v233, v153, v205
	v_mul_f32 v234, v154, v205
	v_mul_f32 v235, v155, v205
	v_mfma_f32_32x32x16_bf16 v[168:183], a[56:59], v[64:67], v[168:183]
	ds_read_b64_tr_b16 a[26:27], v16 offset:512
	ds_read_b64_tr_b16 a[250:251], v248 offset:35840
	ds_read_b64_tr_b16 a[32:33], v18 offset:0
	ds_read_b64_tr_b16 a[252:253], v249 offset:34816
	ds_read_b64_tr_b16 a[34:35], v18 offset:512
	v_exp_f32 v236, v232
	v_exp_f32 v237, v233
	v_exp_f32 v238, v234
	v_exp_f32 v239, v235
	v_fma_f32 v152, v236, 0.5, 1.0
	v_fma_f32 v153, v237, 0.5, 1.0
	v_fma_f32 v154, v238, 0.5, 1.0
	v_fma_f32 v155, v239, 0.5, 1.0
	v_fma_f32 v236, v236, v152, 1.0
	v_fma_f32 v237, v237, v153, 1.0
	v_fma_f32 v238, v238, v154, 1.0
	v_fma_f32 v239, v239, v155, 1.0
	v_rcp_f32 v236, v236
	v_rcp_f32 v237, v237
	v_rcp_f32 v238, v238
	v_mfma_f32_32x32x16_bf16 v[168:183], a[64:67], v[68:71], v[168:183]
	ds_read_b64_tr_b16 a[254:255], v249 offset:35840
	s_mul_i32 s82, s72, 7
	s_add_u32 m0, s80, 32768
	v_rcp_f32 v239, v239
	v_fma_f32 v152, -v232, v236, v232
	v_fma_f32 v153, -v233, v237, v233
	v_fma_f32 v154, -v234, v238, v234
	v_fma_f32 v155, -v235, v239, v235
	v_cvt_pk_bf16_f32 v152, v152, v153
	v_cvt_pk_bf16_f32 v153, v154, v155
	v_mul_f32 v232, v156, v205
	v_mul_f32 v233, v157, v205
	v_mul_f32 v234, v158, v205
	v_mul_f32 v235, v159, v205
	v_exp_f32 v236, v232
	v_exp_f32 v237, v233
	v_exp_f32 v238, v234
	v_exp_f32 v239, v235
	v_fma_f32 v156, v236, 0.5, 1.0
	v_fma_f32 v157, v237, 0.5, 1.0
	v_fma_f32 v158, v238, 0.5, 1.0
	s_waitcnt lgkmcnt(1)
	v_mfma_f32_32x32x16_bf16 v[168:183], a[8:11], v[72:75], v[168:183]
	ds_read_b64_tr_b16 a[40:41], v12 offset:8192
	s_add_u32 s82, s82, s75
	ds_read_b64_tr_b16 a[42:43], v12 offset:8704
	s_add_u32 s55, s53, 20480
	v_fma_f32 v159, v239, 0.5, 1.0
	v_fma_f32 v236, v236, v156, 1.0
	v_fma_f32 v237, v237, v157, 1.0
	v_fma_f32 v238, v238, v158, 1.0
	v_fma_f32 v239, v239, v159, 1.0
	v_rcp_f32 v236, v236
	v_rcp_f32 v237, v237
	v_rcp_f32 v238, v238
	v_rcp_f32 v239, v239
	v_fma_f32 v156, -v232, v236, v232
	v_fma_f32 v157, -v233, v237, v233
	v_fma_f32 v158, -v234, v238, v234
	v_fma_f32 v159, -v235, v239, v235
	v_cvt_pk_bf16_f32 v154, v156, v157
	v_cvt_pk_bf16_f32 v155, v158, v159
	buffer_store_dwordx4 v[152:155], v231, s[12:15], s55 offen sc1
	v_mfma_f32_16x16x32_bf16 a[0:3], a[8:11], a[72:75], a[0:3]
	s_waitcnt lgkmcnt(2)
	buffer_load_dwordx4 v244, s[16:19], s82 offen offset:0 lds
	ds_read_b64_tr_b16 a[48:49], v14 offset:8192
	v_mul_f32 v232, v160, v205
	v_mul_f32 v233, v161, v205
	v_mul_f32 v234, v162, v205
	v_mfma_f32_32x32x16_bf16 v[168:183], a[16:19], v[76:79], v[168:183]
	ds_read_b64_tr_b16 a[50:51], v14 offset:8704
	buffer_load_dwordx4 v245, s[16:19], s82 offen offset:1024 lds
	ds_read_b64_tr_b16 a[56:57], v16 offset:8192
	v_mul_f32 v235, v163, v205
	v_exp_f32 v236, v232
	v_exp_f32 v237, v233
	v_exp_f32 v238, v234
	v_exp_f32 v239, v235
	v_fma_f32 v160, v236, 0.5, 1.0
	v_fma_f32 v161, v237, 0.5, 1.0
	v_fma_f32 v162, v238, 0.5, 1.0
	v_fma_f32 v163, v239, 0.5, 1.0
	v_fma_f32 v236, v236, v160, 1.0
	v_fma_f32 v237, v237, v161, 1.0
	v_fma_f32 v238, v238, v162, 1.0
	v_fma_f32 v239, v239, v163, 1.0
	v_rcp_f32 v236, v236
	v_rcp_f32 v237, v237
	v_mfma_f32_32x32x16_bf16 v[168:183], a[24:27], v[80:83], v[168:183]
	ds_read_b64_tr_b16 a[58:59], v16 offset:8704
	buffer_load_dwordx4 v246, s[16:19], s82 offen offset:2048 lds
	ds_read_b64_tr_b16 a[64:65], v18 offset:8192
	ds_read_b64_tr_b16 a[66:67], v18 offset:8704
	v_rcp_f32 v238, v238
	v_rcp_f32 v239, v239
	v_fma_f32 v160, -v232, v236, v232
	v_fma_f32 v161, -v233, v237, v233
	v_fma_f32 v162, -v234, v238, v234
	v_fma_f32 v163, -v235, v239, v235
	v_cvt_pk_bf16_f32 v160, v160, v161
	v_cvt_pk_bf16_f32 v161, v162, v163
	v_mul_f32 v232, v164, v205
	v_mul_f32 v233, v165, v205
	v_mul_f32 v234, v166, v205
	v_mul_f32 v235, v167, v205
	v_exp_f32 v236, v232
	v_exp_f32 v237, v233
	v_exp_f32 v238, v234
	v_exp_f32 v239, v235
	v_mfma_f32_32x32x16_bf16 v[168:183], a[32:35], v[84:87], v[168:183]
	buffer_load_dwordx4 v247, s[16:19], s82 offen offset:3072 lds
	s_add_u32 s55, s53, 22528
	v_fma_f32 v164, v236, 0.5, 1.0
	v_fma_f32 v165, v237, 0.5, 1.0
	v_fma_f32 v166, v238, 0.5, 1.0
	v_fma_f32 v167, v239, 0.5, 1.0
	v_fma_f32 v236, v236, v164, 1.0
	v_fma_f32 v237, v237, v165, 1.0
	v_fma_f32 v238, v238, v166, 1.0
	v_fma_f32 v239, v239, v167, 1.0
	v_rcp_f32 v236, v236
	v_rcp_f32 v237, v237
	v_rcp_f32 v238, v238
	v_rcp_f32 v239, v239
	v_fma_f32 v164, -v232, v236, v232
	v_fma_f32 v165, -v233, v237, v233
	v_fma_f32 v166, -v234, v238, v234
	v_fma_f32 v167, -v235, v239, v235
	v_cvt_pk_bf16_f32 v162, v164, v165
	v_cvt_pk_bf16_f32 v163, v166, v167
	buffer_store_dwordx4 v[160:163], v231, s[12:15], s55 offen sc1
	s_waitcnt vmcnt(16)
	s_waitcnt lgkmcnt(0)
	s_barrier
	v_mfma_f32_32x32x16_bf16 v[168:183], a[40:43], v[88:91], v[168:183]
	s_mul_i32 s82, s72, 7
	s_add_u32 m0, s81, 0
	s_add_u32 s82, s82, s76
	buffer_load_dwordx4 v244, s[16:19], s82 offen offset:0 lds
	v_add_u32 v12, 136192, v12
	v_add_u32 v14, 136192, v14
	v_add_u32 v16, 136192, v16
	v_add_u32 v18, 136192, v18
	v_mfma_f32_16x16x32_bf16 a[0:3], a[40:43], a[72:75], a[0:3]
	ds_read_b64_tr_b16 a[8:9], v12 offset:0
	v_lshlrev_b32 v220, 4, v0
	v_mfma_f32_32x32x16_bf16 v[168:183], a[48:51], v[92:95], v[168:183]
	ds_read_b64_tr_b16 a[10:11], v12 offset:512
	buffer_load_dwordx4 v245, s[16:19], s82 offen offset:1024 lds
	ds_read_b64_tr_b16 a[16:17], v14 offset:0
	ds_read_b64_tr_b16 a[18:19], v14 offset:512
	buffer_load_dwordx4 v246, s[16:19], s82 offen offset:2048 lds
	v_and_b32 v222, 15, v0
	v_lshrrev_b32 v222, 2, v222
	v_mfma_f32_32x32x16_bf16 v[168:183], a[56:59], v[96:99], v[168:183]
	ds_read_b64_tr_b16 a[24:25], v16 offset:0
	ds_read_b64_tr_b16 a[26:27], v16 offset:512
	buffer_load_dwordx4 v247, s[16:19], s82 offen offset:3072 lds
	ds_read_b64_tr_b16 a[32:33], v18 offset:0
	s_mul_i32 s82, s77, 28672
	v_lshrrev_b32 v223, 5, v0
	v_lshl_add_u32 v223, v223, 2, v222
	v_lshlrev_b32 v223, 7, v223
	v_mfma_f32_32x32x16_bf16 v[168:183], a[64:67], v[100:103], v[168:183]
	ds_read_b64_tr_b16 a[34:35], v18 offset:512
	s_add_u32 m0, s81, 4096
	s_add_u32 s82, s82, s83
	buffer_load_dwordx4 v244, s[16:19], s82 offen offset:0 lds
	v_lshrrev_b32 v222, 1, v222
	v_lshl_or_b32 v223, v222, 6, v223
	v_lshrrev_b32 v222, 4, v0
	v_and_b32 v222, 1, v222
	s_waitcnt lgkmcnt(0)
	v_mfma_f32_32x32x16_bf16 v[168:183], a[8:11], v[104:107], v[168:183]
	buffer_load_dwordx4 v245, s[16:19], s82 offen offset:1024 lds
	ds_read_b64_tr_b16 a[40:41], v12 offset:8192
	ds_read_b64_tr_b16 a[42:43], v12 offset:8704
	buffer_load_dwordx4 v246, s[16:19], s82 offen offset:2048 lds
	v_lshl_or_b32 v223, v222, 5, v223
	v_and_b32 v222, 3, v0
	v_lshl_or_b32 v223, v222, 3, v223
	v_mfma_f32_16x16x32_bf16 a[0:3], a[8:11], a[72:75], a[0:3]
	ds_read_b64_tr_b16 a[48:49], v14 offset:8192
	v_add_u32 v250, s81, v223
	v_mfma_f32_32x32x16_bf16 v[168:183], a[16:19], v[108:111], v[168:183]
	buffer_load_dwordx4 v247, s[16:19], s82 offen offset:3072 lds
	ds_read_b64_tr_b16 a[50:51], v14 offset:8704
	s_mul_i32 s82, s78, 28672
	ds_read_b64_tr_b16 a[56:57], v16 offset:8192
	s_add_u32 m0, s81, 8192
	v_xor_b32 v223, 64, v223
	v_add_u32 v251, s81, v223
	v_lshrrev_b32 v222, 3, v0
	v_mfma_f32_32x32x16_bf16 v[168:183], a[24:27], v[112:115], v[168:183]
	v_mul_u32_u24 v222, 896, v222
	s_waitcnt vmcnt(8)
	v_readfirstlane_b32 s51, v243
	s_cmp_lg_u32 s51, 0
	s_cbranch_scc0 L_rdym_slow
L_rdym_back:
	v_mov_b32 v243, 1
	buffer_atomic_add v243, v240, s[12:15], 0 offen offset:0 sc1
	s_add_u32 s82, s82, s83
	v_and_b32 v223, 7, v0
	v_mfma_f32_32x32x16_bf16 v[168:183], a[32:35], v[116:119], v[168:183]
	ds_read_b64_tr_b16 a[58:59], v16 offset:8704
	buffer_load_dwordx4 v244, s[16:19], s82 offen offset:0 lds
	ds_read_b64_tr_b16 a[64:65], v18 offset:8192
	s_lshl_b32 s56, s35, 6
	ds_read_b64_tr_b16 a[66:67], v18 offset:8704
	s_lshl_b32 s57, s32, 3
	v_lshl_add_u32 v221, v223, 4, v222
	s_waitcnt lgkmcnt(0)
	v_mfma_f32_32x32x16_bf16 v[168:183], a[40:43], v[120:123], v[168:183]
	buffer_load_dwordx4 v245, s[16:19], s82 offen offset:1024 lds
	s_add_u32 s56, s56, s57
	s_mul_i32 s56, s56, 896
	buffer_load_dwordx4 v246, s[16:19], s82 offen offset:2048 lds
	s_lshl_b32 s57, s36, 7
	buffer_load_dwordx4 v247, s[16:19], s82 offen offset:3072 lds
	s_add_u32 s44, s56, s57
	v_mfma_f32_16x16x32_bf16 a[0:3], a[40:43], a[72:75], a[0:3]
	s_mul_i32 s41, s35, 229376
	v_mfma_f32_32x32x16_bf16 v[168:183], a[48:51], v[124:127], v[168:183]
	s_mul_i32 s82, s79, 28672
	s_add_u32 s41, s41, 0
	s_add_u32 m0, s81, 12288
	s_lshl_b32 s56, s32, 13
	s_add_u32 s82, s82, s83
	s_add_u32 s40, s41, s56
	buffer_load_dwordx4 v244, s[16:19], s82 offen offset:0 lds
	s_lshl_b32 s56, s35, 16
	v_mfma_f32_32x32x16_bf16 v[168:183], a[56:59], v[128:131], v[168:183]
	s_add_u32 s56, s56, 7340032
	buffer_load_dwordx4 v245, s[16:19], s82 offen offset:1024 lds
	s_mov_b32 s42, 28672
	s_mov_b32 s43, 20480
	buffer_load_dwordx4 v246, s[16:19], s82 offen offset:2048 lds
	buffer_load_dwordx4 v247, s[16:19], s82 offen offset:3072 lds
	v_mfma_f32_32x32x16_bf16 v[168:183], a[64:67], v[132:135], v[168:183]
	s_cmp_eq_u32 s32, 3
	s_cselect_b32 s40, s56, s40
	s_cselect_b32 s42, 4096, s42
	s_cselect_b32 s43, 4096, s43
	s_cselect_b32 s45, 0, 256
	s_mov_b64 exec, s[60:61]
	ds_write_b128 v200, a[0:3] offset:1024
	s_mov_b64 exec, -1
	s_waitcnt lgkmcnt(0)
	s_barrier
	ds_read_b32 v224, v201 offset:1024
	ds_read_b32 v225, v201 offset:1280
	ds_read_b32 v226, v201 offset:1536
	ds_read_b32 v227, v201 offset:1792
	ds_read_u16 v8, v11
	buffer_load_dword v242, v241, s[12:15], 0 offen sc1
	s_waitcnt lgkmcnt(3)
	v_add_f32 v224, v224, v225
	s_waitcnt lgkmcnt(1)
	v_add_f32 v226, v226, v227
	v_add_f32 v224, v224, v226
	v_cvt_pk_bf16_f32 v212, v224, v224
	v_and_b32 v225, 0xffff0000, v212
	v_sub_f32 v225, v224, v225
	s_waitcnt lgkmcnt(0)
	v_lshlrev_b32 v8, 16, v8
	v_cvt_pk_bf16_f32 v213, v225, v8
	v_cvt_pk_bf16_f32 v214, v8, v215
	s_nop 1
	v_mfma_f32_32x32x16_bf16 v[168:183], v[212:215], v[208:211], v[168:183]
	s_nop 11
	v_pk_mul_f32 v[232:233], v[168:169], v[204:205] op_sel:[0,1] op_sel_hi:[1,1]
	v_pk_mul_f32 v[234:235], v[170:171], v[204:205] op_sel:[0,1] op_sel_hi:[1,1]
	v_exp_f32 v236, v232
	v_exp_f32 v237, v233
	v_exp_f32 v238, v234
	v_exp_f32 v239, v235
	v_pk_fma_f32 v[168:169], v[236:237], 0.5, 1.0 op_sel_hi:[1,0,0]
	v_pk_fma_f32 v[170:171], v[238:239], 0.5, 1.0 op_sel_hi:[1,0,0]
	v_pk_fma_f32 v[236:237], v[236:237], v[168:169], 1.0 op_sel_hi:[1,1,0]
	v_pk_fma_f32 v[238:239], v[238:239], v[170:171], 1.0 op_sel_hi:[1,1,0]
	v_rcp_f32 v236, v236
	v_rcp_f32 v237, v237
	v_rcp_f32 v238, v238
	v_rcp_f32 v239, v239
	v_pk_fma_f32 v[168:169], v[232:233], v[236:237], v[232:233] neg_lo:[1,0,0] neg_hi:[1,0,0]
	v_pk_fma_f32 v[170:171], v[234:235], v[238:239], v[234:235] neg_lo:[1,0,0] neg_hi:[1,0,0]
	v_cvt_pk_bf16_f32 v168, v168, v169
	v_cvt_pk_bf16_f32 v169, v170, v171
	v_pk_mul_f32 v[232:233], v[172:173], v[204:205] op_sel:[0,1] op_sel_hi:[1,1]
	v_pk_mul_f32 v[234:235], v[174:175], v[204:205] op_sel:[0,1] op_sel_hi:[1,1]
	v_exp_f32 v236, v232
	v_exp_f32 v237, v233
	buffer_load_dword v216, v241, s[12:15], 0 offen sc1
	v_exp_f32 v238, v234
	v_exp_f32 v239, v235
	v_pk_fma_f32 v[172:173], v[236:237], 0.5, 1.0 op_sel_hi:[1,0,0]
	v_pk_fma_f32 v[174:175], v[238:239], 0.5, 1.0 op_sel_hi:[1,0,0]
	v_pk_fma_f32 v[236:237], v[236:237], v[172:173], 1.0 op_sel_hi:[1,1,0]
	v_pk_fma_f32 v[238:239], v[238:239], v[174:175], 1.0 op_sel_hi:[1,1,0]
	v_rcp_f32 v236, v236
	v_rcp_f32 v237, v237
	v_rcp_f32 v238, v238
	v_rcp_f32 v239, v239
	v_pk_fma_f32 v[172:173], v[232:233], v[236:237], v[232:233] neg_lo:[1,0,0] neg_hi:[1,0,0]
	v_pk_fma_f32 v[174:175], v[234:235], v[238:239], v[234:235] neg_lo:[1,0,0] neg_hi:[1,0,0]
	v_cvt_pk_bf16_f32 v170, v172, v173
	v_cvt_pk_bf16_f32 v171, v174, v175
	s_add_u32 s55, s54, 0
	buffer_store_dwordx4 v[168:171], v231, s[12:15], s55 offen sc1
	v_pk_mul_f32 v[232:233], v[176:177], v[204:205] op_sel:[0,1] op_sel_hi:[1,1]
	v_pk_mul_f32 v[234:235], v[178:179], v[204:205] op_sel:[0,1] op_sel_hi:[1,1]
	v_exp_f32 v236, v232
	v_exp_f32 v237, v233
	v_exp_f32 v238, v234
	v_exp_f32 v239, v235
	v_pk_fma_f32 v[176:177], v[236:237], 0.5, 1.0 op_sel_hi:[1,0,0]
	v_pk_fma_f32 v[178:179], v[238:239], 0.5, 1.0 op_sel_hi:[1,0,0]
	v_pk_fma_f32 v[236:237], v[236:237], v[176:177], 1.0 op_sel_hi:[1,1,0]
	v_pk_fma_f32 v[238:239], v[238:239], v[178:179], 1.0 op_sel_hi:[1,1,0]
	v_rcp_f32 v236, v236
	v_rcp_f32 v237, v237
	v_rcp_f32 v238, v238
	v_rcp_f32 v239, v239
	v_pk_fma_f32 v[176:177], v[232:233], v[236:237], v[232:233] neg_lo:[1,0,0] neg_hi:[1,0,0]
	v_pk_fma_f32 v[178:179], v[234:235], v[238:239], v[234:235] neg_lo:[1,0,0] neg_hi:[1,0,0]
	v_cvt_pk_bf16_f32 v176, v176, v177
	v_cvt_pk_bf16_f32 v177, v178, v179
	v_pk_mul_f32 v[232:233], v[180:181], v[204:205] op_sel:[0,1] op_sel_hi:[1,1]
	v_pk_mul_f32 v[234:235], v[182:183], v[204:205] op_sel:[0,1] op_sel_hi:[1,1]
	v_exp_f32 v236, v232
	v_exp_f32 v237, v233
	v_exp_f32 v238, v234
	v_exp_f32 v239, v235
	v_pk_fma_f32 v[180:181], v[236:237], 0.5, 1.0 op_sel_hi:[1,0,0]
	v_pk_fma_f32 v[182:183], v[238:239], 0.5, 1.0 op_sel_hi:[1,0,0]
	v_pk_fma_f32 v[236:237], v[236:237], v[180:181], 1.0 op_sel_hi:[1,1,0]
	v_pk_fma_f32 v[238:239], v[238:239], v[182:183], 1.0 op_sel_hi:[1,1,0]
	v_rcp_f32 v236, v236
	v_rcp_f32 v237, v237
	v_rcp_f32 v238, v238
	v_rcp_f32 v239, v239
	v_pk_fma_f32 v[180:181], v[232:233], v[236:237], v[232:233] neg_lo:[1,0,0] neg_hi:[1,0,0]
	v_pk_fma_f32 v[182:183], v[234:235], v[238:239], v[234:235] neg_lo:[1,0,0] neg_hi:[1,0,0]
	v_cvt_pk_bf16_f32 v178, v180, v181
	v_cvt_pk_bf16_f32 v179, v182, v183
	s_add_u32 s55, s54, 2048
	buffer_store_dwordx4 v[176:179], v231, s[12:15], s55 offen sc1
	buffer_load_dword v217, v241, s[12:15], 0 offen sc1
	s_waitcnt lgkmcnt(0)
	s_waitcnt vmcnt(4)
L_f_p1done:
	v_readfirstlane_b32 s51, v242
	s_cmp_ge_u32 s51, 32
	s_cbranch_scc0 L_early_slow
L_early_back:
	buffer_load_dwordx4 v[68:71], v220, s[12:15], s40 offen offset:0 sc1
	buffer_load_dwordx4 v[72:75], v220, s[12:15], s40 offen offset:1024 sc1
	buffer_load_dwordx4 v[76:79], v220, s[12:15], s40 offen offset:2048 sc1
	buffer_load_dwordx4 v[80:83], v220, s[12:15], s40 offen offset:3072 sc1
	s_add_u32 s40, s40, 4096
	buffer_load_dwordx4 v[84:87], v220, s[12:15], s40 offen offset:0 sc1
	buffer_load_dwordx4 v[88:91], v220, s[12:15], s40 offen offset:1024 sc1
	buffer_load_dwordx4 v[92:95], v220, s[12:15], s40 offen offset:2048 sc1
	buffer_load_dwordx4 v[96:99], v220, s[12:15], s40 offen offset:3072 sc1
	s_add_u32 s40, s40, s42
	buffer_load_dwordx4 v[100:103], v220, s[12:15], s40 offen offset:0 sc1
	buffer_load_dwordx4 v[104:107], v220, s[12:15], s40 offen offset:1024 sc1
	buffer_load_dwordx4 v[108:111], v220, s[12:15], s40 offen offset:2048 sc1
	buffer_load_dwordx4 v[112:115], v220, s[12:15], s40 offen offset:3072 sc1
	s_waitcnt vmcnt(10)
	v_mfma_f32_32x32x16_bf16 v[4:19], a[80:83], v[68:71], 0
	s_add_u32 s40, s40, 4096
	buffer_load_dwordx4 v[116:119], v220, s[12:15], s40 offen offset:0 sc1
	buffer_load_dwordx4 v[120:123], v220, s[12:15], s40 offen offset:1024 sc1
	v_mfma_f32_32x32x16_bf16 v[36:51], a[84:87], v[68:71], 0
	buffer_load_dwordx4 v[124:127], v220, s[12:15], s40 offen offset:2048 sc1
	buffer_load_dwordx4 v[128:131], v220, s[12:15], s40 offen offset:3072 sc1
	buffer_atomic_add v243, v240, s[12:15], 0 offen offset:256 sc1
	v_mfma_f32_32x32x16_bf16 v[20:35], a[80:83], v[72:75], 0
	v_mfma_f32_32x32x16_bf16 v[52:67], a[84:87], v[72:75], 0
	s_waitcnt vmcnt(13)
	v_mfma_f32_32x32x16_bf16 v[4:19], a[88:91], v[76:79], v[4:19]
	v_mfma_f32_32x32x16_bf16 v[36:51], a[92:95], v[76:79], v[36:51]
	v_mfma_f32_32x32x16_bf16 v[20:35], a[88:91], v[80:83], v[20:35]
	v_mfma_f32_32x32x16_bf16 v[52:67], a[92:95], v[80:83], v[52:67]
	s_waitcnt vmcnt(11)
	v_mfma_f32_32x32x16_bf16 v[4:19], a[96:99], v[84:87], v[4:19]
	s_add_u32 s40, s40, s43
	buffer_load_dwordx4 v[132:135], v220, s[12:15], s40 offen offset:0 sc1
	buffer_load_dwordx4 v[136:139], v220, s[12:15], s40 offen offset:1024 sc1
	v_mfma_f32_32x32x16_bf16 v[36:51], a[100:103], v[84:87], v[36:51]
	buffer_load_dwordx4 v[140:143], v220, s[12:15], s40 offen offset:2048 sc1
	buffer_load_dwordx4 v[144:147], v220, s[12:15], s40 offen offset:3072 sc1
	v_mfma_f32_32x32x16_bf16 v[20:35], a[96:99], v[88:91], v[20:35]
	v_mfma_f32_32x32x16_bf16 v[52:67], a[100:103], v[88:91], v[52:67]
	s_waitcnt vmcnt(13)
	v_mfma_f32_32x32x16_bf16 v[4:19], a[104:107], v[92:95], v[4:19]
	v_mfma_f32_32x32x16_bf16 v[36:51], a[108:111], v[92:95], v[36:51]
	v_mfma_f32_32x32x16_bf16 v[20:35], a[104:107], v[96:99], v[20:35]
	v_mfma_f32_32x32x16_bf16 v[52:67], a[108:111], v[96:99], v[52:67]
	s_waitcnt vmcnt(11)
	v_mfma_f32_32x32x16_bf16 v[4:19], a[112:115], v[100:103], v[4:19]
	s_add_u32 s40, s40, 4096
	buffer_load_dwordx4 v[148:151], v220, s[12:15], s40 offen offset:0 sc1
	buffer_load_dwordx4 v[152:155], v220, s[12:15], s40 offen offset:1024 sc1
	v_mfma_f32_32x32x16_bf16 v[36:51], a[116:119], v[100:103], v[36:51]
	buffer_load_dwordx4 v[156:159], v220, s[12:15], s40 offen offset:2048 sc1
	buffer_load_dwordx4 v[160:163], v220, s[12:15], s40 offen offset:3072 sc1
	v_mfma_f32_32x32x16_bf16 v[20:35], a[112:115], v[104:107], v[20:35]
	v_mfma_f32_32x32x16_bf16 v[52:67], a[116:119], v[104:107], v[52:67]
	s_waitcnt vmcnt(13)
	v_mfma_f32_32x32x16_bf16 v[4:19], a[120:123], v[108:111], v[4:19]
	v_mfma_f32_32x32x16_bf16 v[36:51], a[124:127], v[108:111], v[36:51]
	v_mfma_f32_32x32x16_bf16 v[20:35], a[120:123], v[112:115], v[20:35]
	v_mfma_f32_32x32x16_bf16 v[52:67], a[124:127], v[112:115], v[52:67]
	s_waitcnt vmcnt(11)
	v_mfma_f32_32x32x16_bf16 v[4:19], a[128:131], v[116:119], v[4:19]
	s_add_u32 s40, s40, s42
	buffer_load_dwordx4 v[164:167], v220, s[12:15], s40 offen offset:0 sc1
	buffer_load_dwordx4 v[168:171], v220, s[12:15], s40 offen offset:1024 sc1
	v_mfma_f32_32x32x16_bf16 v[36:51], a[132:135], v[116:119], v[36:51]
	buffer_load_dwordx4 v[172:175], v220, s[12:15], s40 offen offset:2048 sc1
	buffer_load_dwordx4 v[176:179], v220, s[12:15], s40 offen offset:3072 sc1
	v_mfma_f32_32x32x16_bf16 v[20:35], a[128:131], v[120:123], v[20:35]
	v_mfma_f32_32x32x16_bf16 v[52:67], a[132:135], v[120:123], v[52:67]
	s_waitcnt vmcnt(13)
	v_mfma_f32_32x32x16_bf16 v[4:19], a[136:139], v[124:127], v[4:19]
	v_mfma_f32_32x32x16_bf16 v[36:51], a[140:143], v[124:127], v[36:51]
	v_mfma_f32_32x32x16_bf16 v[20:35], a[136:139], v[128:131], v[20:35]
	v_mfma_f32_32x32x16_bf16 v[52:67], a[140:143], v[128:131], v[52:67]
	s_waitcnt vmcnt(10)
	v_mfma_f32_32x32x16_bf16 v[4:19], a[144:147], v[132:135], v[4:19]
	s_add_u32 s40, s40, 4096
	buffer_load_dwordx4 v[180:183], v220, s[12:15], s40 offen offset:0 sc1
	buffer_load_dwordx4 v[184:187], v220, s[12:15], s40 offen offset:1024 sc1
	v_mfma_f32_32x32x16_bf16 v[36:51], a[148:151], v[132:135], v[36:51]
	buffer_load_dwordx4 v[188:191], v220, s[12:15], s40 offen offset:2048 sc1
	buffer_load_dwordx4 v[192:195], v220, s[12:15], s40 offen offset:3072 sc1
	v_mfma_f32_32x32x16_bf16 v[20:35], a[144:147], v[136:139], v[20:35]
	v_mfma_f32_32x32x16_bf16 v[52:67], a[148:151], v[136:139], v[52:67]
	s_waitcnt vmcnt(12)
	v_mfma_f32_32x32x16_bf16 v[4:19], a[152:155], v[140:143], v[4:19]
	v_mfma_f32_32x32x16_bf16 v[36:51], a[156:159], v[140:143], v[36:51]
	v_mfma_f32_32x32x16_bf16 v[20:35], a[152:155], v[144:147], v[20:35]
	v_mfma_f32_32x32x16_bf16 v[52:67], a[156:159], v[144:147], v[52:67]
	s_waitcnt vmcnt(10)
	v_mfma_f32_32x32x16_bf16 v[4:19], a[160:163], v[148:151], v[4:19]
	s_add_u32 s40, s40, s43
	buffer_load_dwordx4 v[68:71], v220, s[12:15], s40 offen offset:0 sc1
	buffer_load_dwordx4 v[72:75], v220, s[12:15], s40 offen offset:1024 sc1
	v_mfma_f32_32x32x16_bf16 v[36:51], a[164:167], v[148:151], v[36:51]
	buffer_load_dwordx4 v[76:79], v220, s[12:15], s40 offen offset:2048 sc1
	buffer_load_dwordx4 v[80:83], v220, s[12:15], s40 offen offset:3072 sc1
	v_mfma_f32_32x32x16_bf16 v[20:35], a[160:163], v[152:155], v[20:35]
	v_mfma_f32_32x32x16_bf16 v[52:67], a[164:167], v[152:155], v[52:67]
	s_waitcnt vmcnt(12)
	v_mfma_f32_32x32x16_bf16 v[4:19], a[168:171], v[156:159], v[4:19]
	v_mfma_f32_32x32x16_bf16 v[36:51], a[172:175], v[156:159], v[36:51]
	v_mfma_f32_32x32x16_bf16 v[20:35], a[168:171], v[160:163], v[20:35]
	v_mfma_f32_32x32x16_bf16 v[52:67], a[172:175], v[160:163], v[52:67]
	s_waitcnt vmcnt(10)
	v_mfma_f32_32x32x16_bf16 v[4:19], a[176:179], v[164:167], v[4:19]
	s_add_u32 s40, s40, 4096
	buffer_load_dwordx4 v[84:87], v220, s[12:15], s40 offen offset:0 sc1
	buffer_load_dwordx4 v[88:91], v220, s[12:15], s40 offen offset:1024 sc1
	v_mfma_f32_32x32x16_bf16 v[36:51], a[180:183], v[164:167], v[36:51]
	buffer_load_dwordx4 v[92:95], v220, s[12:15], s40 offen offset:2048 sc1
	buffer_load_dwordx4 v[96:99], v220, s[12:15], s40 offen offset:3072 sc1
	v_mfma_f32_32x32x16_bf16 v[20:35], a[176:179], v[168:171], v[20:35]
	v_mfma_f32_32x32x16_bf16 v[52:67], a[180:183], v[168:171], v[52:67]
	s_waitcnt vmcnt(12)
	v_mfma_f32_32x32x16_bf16 v[4:19], a[184:187], v[172:175], v[4:19]
	v_mfma_f32_32x32x16_bf16 v[36:51], a[188:191], v[172:175], v[36:51]
	v_mfma_f32_32x32x16_bf16 v[20:35], a[184:187], v[176:179], v[20:35]
	v_mfma_f32_32x32x16_bf16 v[52:67], a[188:191], v[176:179], v[52:67]
	s_waitcnt vmcnt(10)
	v_mfma_f32_32x32x16_bf16 v[4:19], a[192:195], v[180:183], v[4:19]
	s_add_u32 s40, s40, s42
	buffer_load_dwordx4 v[100:103], v220, s[12:15], s40 offen offset:0 sc1
	buffer_load_dwordx4 v[104:107], v220, s[12:15], s40 offen offset:1024 sc1
	v_mfma_f32_32x32x16_bf16 v[36:51], a[196:199], v[180:183], v[36:51]
	buffer_load_dwordx4 v[108:111], v220, s[12:15], s40 offen offset:2048 sc1
	buffer_load_dwordx4 v[112:115], v220, s[12:15], s40 offen offset:3072 sc1
	v_mfma_f32_32x32x16_bf16 v[20:35], a[192:195], v[184:187], v[20:35]
	v_mfma_f32_32x32x16_bf16 v[52:67], a[196:199], v[184:187], v[52:67]
	s_waitcnt vmcnt(12)
	v_mfma_f32_32x32x16_bf16 v[4:19], a[200:203], v[188:191], v[4:19]
	v_mfma_f32_32x32x16_bf16 v[36:51], a[204:207], v[188:191], v[36:51]
	v_mfma_f32_32x32x16_bf16 v[20:35], a[200:203], v[192:195], v[20:35]
	v_mfma_f32_32x32x16_bf16 v[52:67], a[204:207], v[192:195], v[52:67]
	s_waitcnt vmcnt(10)
	v_mfma_f32_32x32x16_bf16 v[4:19], a[208:211], v[68:71], v[4:19]
	s_add_u32 s40, s40, 4096
	buffer_load_dwordx4 v[116:119], v220, s[12:15], s40 offen offset:0 sc1
	buffer_load_dwordx4 v[120:123], v220, s[12:15], s40 offen offset:1024 sc1
	v_mfma_f32_32x32x16_bf16 v[36:51], a[212:215], v[68:71], v[36:51]
	buffer_load_dwordx4 v[124:127], v220, s[12:15], s40 offen offset:2048 sc1
	buffer_load_dwordx4 v[128:131], v220, s[12:15], s40 offen offset:3072 sc1
	v_mfma_f32_32x32x16_bf16 v[20:35], a[208:211], v[72:75], v[20:35]
	v_mfma_f32_32x32x16_bf16 v[52:67], a[212:215], v[72:75], v[52:67]
	s_waitcnt vmcnt(12)
	v_mfma_f32_32x32x16_bf16 v[4:19], a[216:219], v[76:79], v[4:19]
	v_mfma_f32_32x32x16_bf16 v[36:51], a[220:223], v[76:79], v[36:51]
	v_mfma_f32_32x32x16_bf16 v[20:35], a[216:219], v[80:83], v[20:35]
	v_mfma_f32_32x32x16_bf16 v[52:67], a[220:223], v[80:83], v[52:67]
	s_waitcnt vmcnt(10)
	v_mfma_f32_32x32x16_bf16 v[4:19], a[224:227], v[84:87], v[4:19]
	s_add_u32 s40, s40, s43
	buffer_load_dwordx4 v[132:135], v220, s[12:15], s40 offen offset:0 sc1
	buffer_load_dwordx4 v[136:139], v220, s[12:15], s40 offen offset:1024 sc1
	v_mfma_f32_32x32x16_bf16 v[36:51], a[228:231], v[84:87], v[36:51]
	buffer_load_dwordx4 v[140:143], v220, s[12:15], s40 offen offset:2048 sc1
	buffer_load_dwordx4 v[144:147], v220, s[12:15], s40 offen offset:3072 sc1
	v_mfma_f32_32x32x16_bf16 v[20:35], a[224:227], v[88:91], v[20:35]
	v_mfma_f32_32x32x16_bf16 v[52:67], a[228:231], v[88:91], v[52:67]
	s_waitcnt vmcnt(12)
	v_mfma_f32_32x32x16_bf16 v[4:19], a[232:235], v[92:95], v[4:19]
	v_mfma_f32_32x32x16_bf16 v[36:51], a[236:239], v[92:95], v[36:51]
	v_mfma_f32_32x32x16_bf16 v[20:35], a[232:235], v[96:99], v[20:35]
	v_mfma_f32_32x32x16_bf16 v[52:67], a[236:239], v[96:99], v[52:67]
	s_waitcnt vmcnt(10)
	v_mfma_f32_32x32x16_bf16 v[4:19], a[240:243], v[100:103], v[4:19]
	s_add_u32 s40, s40, 4096
	buffer_load_dwordx4 v[148:151], v220, s[12:15], s40 offen offset:0 sc1
	buffer_load_dwordx4 v[152:155], v220, s[12:15], s40 offen offset:1024 sc1
	v_mfma_f32_32x32x16_bf16 v[36:51], a[244:247], v[100:103], v[36:51]
	buffer_load_dwordx4 v[156:159], v220, s[12:15], s40 offen offset:2048 sc1
	buffer_load_dwordx4 v[160:163], v220, s[12:15], s40 offen offset:3072 sc1
	buffer_load_dword v242, v241, s[12:15], s45 offen sc1
	v_mfma_f32_32x32x16_bf16 v[20:35], a[240:243], v[104:107], v[20:35]
	v_mfma_f32_32x32x16_bf16 v[52:67], a[244:247], v[104:107], v[52:67]
	s_waitcnt vmcnt(13)
	v_mfma_f32_32x32x16_bf16 v[4:19], a[248:251], v[108:111], v[4:19]
	ds_read_b64_tr_b16 v[196:197], v248 offset:49152
	ds_read_b64_tr_b16 v[198:199], v248 offset:50176
	ds_read_b64_tr_b16 v[200:201], v249 offset:49152
	ds_read_b64_tr_b16 v[202:203], v249 offset:50176
	v_mfma_f32_32x32x16_bf16 v[36:51], a[252:255], v[108:111], v[36:51]
	v_mfma_f32_32x32x16_bf16 v[20:35], a[248:251], v[112:115], v[20:35]
	v_mfma_f32_32x32x16_bf16 v[52:67], a[252:255], v[112:115], v[52:67]
	s_waitcnt vmcnt(11) lgkmcnt(0)
	v_mfma_f32_32x32x16_bf16 v[4:19], v[196:199], v[116:119], v[4:19]
	s_add_u32 s40, s40, s42
	ds_read_b64_tr_b16 v[204:205], v248 offset:51200
	ds_read_b64_tr_b16 v[206:207], v248 offset:52224
	buffer_load_dwordx4 v[164:167], v220, s[12:15], s40 offen offset:0 sc1
	ds_read_b64_tr_b16 v[208:209], v249 offset:51200
	v_mfma_f32_32x32x16_bf16 v[36:51], v[200:203], v[116:119], v[36:51]
	ds_read_b64_tr_b16 v[210:211], v249 offset:52224
	buffer_load_dwordx4 v[168:171], v220, s[12:15], s40 offen offset:1024 sc1
	buffer_load_dwordx4 v[172:175], v220, s[12:15], s40 offen offset:2048 sc1
	v_mfma_f32_32x32x16_bf16 v[20:35], v[196:199], v[120:123], v[20:35]
	buffer_load_dwordx4 v[176:179], v220, s[12:15], s40 offen offset:3072 sc1
	v_mfma_f32_32x32x16_bf16 v[52:67], v[200:203], v[120:123], v[52:67]
	s_waitcnt vmcnt(13) lgkmcnt(0)
	v_mfma_f32_32x32x16_bf16 v[4:19], v[204:207], v[124:127], v[4:19]
	ds_read_b64_tr_b16 v[196:197], v248 offset:0
	ds_read_b64_tr_b16 v[198:199], v248 offset:1024
	ds_read_b64_tr_b16 v[200:201], v249 offset:0
	ds_read_b64_tr_b16 v[202:203], v249 offset:1024
	v_mfma_f32_32x32x16_bf16 v[36:51], v[208:211], v[124:127], v[36:51]
	v_mfma_f32_32x32x16_bf16 v[20:35], v[204:207], v[128:131], v[20:35]
	v_mfma_f32_32x32x16_bf16 v[52:67], v[208:211], v[128:131], v[52:67]
	s_waitcnt vmcnt(11) lgkmcnt(0)
	v_mfma_f32_32x32x16_bf16 v[4:19], v[196:199], v[132:135], v[4:19]
	s_add_u32 s40, s40, 4096
	ds_read_b64_tr_b16 v[204:205], v248 offset:2048
	ds_read_b64_tr_b16 v[206:207], v248 offset:3072
	buffer_load_dwordx4 v[180:183], v220, s[12:15], s40 offen offset:0 sc1
	ds_read_b64_tr_b16 v[208:209], v249 offset:2048
	v_mfma_f32_32x32x16_bf16 v[36:51], v[200:203], v[132:135], v[36:51]
	ds_read_b64_tr_b16 v[210:211], v249 offset:3072
	buffer_load_dwordx4 v[184:187], v220, s[12:15], s40 offen offset:1024 sc1
	buffer_load_dwordx4 v[188:191], v220, s[12:15], s40 offen offset:2048 sc1
	v_mfma_f32_32x32x16_bf16 v[20:35], v[196:199], v[136:139], v[20:35]
	buffer_load_dwordx4 v[192:195], v220, s[12:15], s40 offen offset:3072 sc1
	v_mfma_f32_32x32x16_bf16 v[52:67], v[200:203], v[136:139], v[52:67]
	s_waitcnt vmcnt(13) lgkmcnt(0)
	v_mfma_f32_32x32x16_bf16 v[4:19], v[204:207], v[140:143], v[4:19]
	ds_read_b64_tr_b16 v[196:197], v248 offset:16384
	ds_read_b64_tr_b16 v[198:199], v248 offset:17408
	ds_read_b64_tr_b16 v[200:201], v249 offset:16384
	ds_read_b64_tr_b16 v[202:203], v249 offset:17408
	v_mfma_f32_32x32x16_bf16 v[36:51], v[208:211], v[140:143], v[36:51]
	v_mfma_f32_32x32x16_bf16 v[20:35], v[204:207], v[144:147], v[20:35]
	v_mfma_f32_32x32x16_bf16 v[52:67], v[208:211], v[144:147], v[52:67]
	s_cmp_eq_u32 s32, 3
	s_cbranch_scc1 L_p2_w3
	s_waitcnt vmcnt(8)
	v_readfirstlane_b32 s51, v242
	s_cmp_ge_u32 s51, 32
	s_cbranch_scc0 L_late_slow
L_late_back:
	s_waitcnt lgkmcnt(0)
	v_mfma_f32_32x32x16_bf16 v[4:19], v[196:199], v[148:151], v[4:19]
	s_lshl_b32 s52, s77, 12
	s_add_u32 s52, s52, s41
	ds_read_b64_tr_b16 v[204:205], v248 offset:18432
	buffer_load_dwordx4 v[68:71], v220, s[12:15], s52 offen offset:0 sc1
	ds_read_b64_tr_b16 v[206:207], v248 offset:19456
	v_mfma_f32_32x32x16_bf16 v[36:51], v[200:203], v[148:151], v[36:51]
	buffer_load_dwordx4 v[76:79], v220, s[12:15], s52 offen offset:2048 sc1
	ds_read_b64_tr_b16 v[208:209], v249 offset:18432
	s_lshl_b32 s53, s78, 12
	s_add_u32 s53, s53, s41
	ds_read_b64_tr_b16 v[210:211], v249 offset:19456
	v_mfma_f32_32x32x16_bf16 v[20:35], v[196:199], v[152:155], v[20:35]
	buffer_load_dwordx4 v[84:87], v220, s[12:15], s53 offen offset:0 sc1
	buffer_load_dwordx4 v[92:95], v220, s[12:15], s53 offen offset:2048 sc1
	v_and_b32 v222, 31, v0
	v_lshlrev_b32 v227, 8, v222
	v_mfma_f32_32x32x16_bf16 v[52:67], v[200:203], v[152:155], v[52:67]
	v_add_u32 v227, s81, v227
	v_and_b32 v222, 15, v0
	v_lshrrev_b32 v224, 5, v0
	v_xor_b32 v222, v222, v224
	s_waitcnt lgkmcnt(0)
	v_mfma_f32_32x32x16_bf16 v[4:19], v[204:207], v[156:159], v[4:19]
	ds_read_b64_tr_b16 v[196:197], v248 offset:32768
	ds_read_b64_tr_b16 v[198:199], v248 offset:33792
	ds_read_b64_tr_b16 v[200:201], v249 offset:32768
	v_lshl_add_u32 v227, v222, 4, v227
	v_xor_b32 v228, 32, v227
	v_xor_b32 v229, 64, v227
	v_mfma_f32_32x32x16_bf16 v[36:51], v[208:211], v[156:159], v[36:51]
	ds_read_b64_tr_b16 v[202:203], v249 offset:33792
	v_xor_b32 v230, 96, v227
	v_xor_b32 v231, 128, v227
	v_xor_b32 v232, 160, v227
	v_mfma_f32_32x32x16_bf16 v[20:35], v[204:207], v[160:163], v[20:35]
	v_mfma_f32_32x32x16_bf16 v[52:67], v[208:211], v[160:163], v[52:67]
	s_waitcnt vmcnt(10) lgkmcnt(0)
	v_mfma_f32_32x32x16_bf16 v[4:19], v[196:199], v[164:167], v[4:19]
	s_lshl_b32 s54, s79, 12
	s_add_u32 s54, s54, s41
	ds_read_b64_tr_b16 v[204:205], v248 offset:34816
	buffer_load_dwordx4 v[100:103], v220, s[12:15], s54 offen offset:0 sc1
	ds_read_b64_tr_b16 v[206:207], v248 offset:35840
	v_mfma_f32_32x32x16_bf16 v[36:51], v[200:203], v[164:167], v[36:51]
	buffer_load_dwordx4 v[108:111], v220, s[12:15], s54 offen offset:2048 sc1
	buffer_load_dwordx4 v[72:75], v220, s[12:15], s52 offen offset:1024 sc1
	ds_read_b64_tr_b16 v[208:209], v249 offset:34816
	buffer_load_dwordx4 v[80:83], v220, s[12:15], s52 offen offset:3072 sc1
	v_mfma_f32_32x32x16_bf16 v[20:35], v[196:199], v[168:171], v[20:35]
	ds_read_b64_tr_b16 v[210:211], v249 offset:35840
	s_add_u32 s47, s44, 0
	buffer_load_dwordx4 v[212:215], v221, s[4:7], s47 offen
	s_add_u32 s47, s44, 28672
	buffer_load_dwordx4 v[216:219], v221, s[4:7], s47 offen
	v_mfma_f32_32x32x16_bf16 v[52:67], v[200:203], v[168:171], v[52:67]
	s_lshl_b32 s49, s32, 3
	v_xor_b32 v233, 192, v227
	v_xor_b32 v234, 224, v227
	v_lshrrev_b32 v222, 3, v0
	v_add_u32 v222, s49, v222
	v_and_b32 v223, 7, v0
	s_waitcnt vmcnt(14) lgkmcnt(0)
	v_mfma_f32_32x32x16_bf16 v[4:19], v[204:207], v[172:175], v[4:19]
	ds_read_b64_tr_b16 v[196:197], v250 offset:0
	ds_read_b64_tr_b16 v[198:199], v250 offset:1024
	ds_read_b64_tr_b16 v[200:201], v251 offset:0
	v_lshlrev_b32 v223, 1, v223
	v_and_b32 v224, 15, v222
	v_xor_b32 v224, v224, v223
	v_mfma_f32_32x32x16_bf16 v[36:51], v[208:211], v[172:175], v[36:51]
	ds_read_b64_tr_b16 v[202:203], v251 offset:1024
	v_lshlrev_b32 v224, 4, v224
	v_lshl_add_u32 v225, v222, 8, v224
	v_lshrrev_b32 v224, 1, v222
	v_mfma_f32_32x32x16_bf16 v[20:35], v[204:207], v[176:179], v[20:35]
	v_mfma_f32_32x32x16_bf16 v[52:67], v[208:211], v[176:179], v[52:67]
	s_waitcnt vmcnt(12) lgkmcnt(0)
	v_mfma_f32_32x32x16_bf16 v[4:19], v[196:199], v[180:183], v[4:19]
	buffer_load_dwordx4 v[88:91], v220, s[12:15], s53 offen offset:1024 sc1
	ds_read_b64_tr_b16 v[204:205], v250 offset:2048
	buffer_load_dwordx4 v[96:99], v220, s[12:15], s53 offen offset:3072 sc1
	ds_read_b64_tr_b16 v[206:207], v250 offset:3072
	v_mfma_f32_32x32x16_bf16 v[36:51], v[200:203], v[180:183], v[36:51]
	ds_read_b64_tr_b16 v[208:209], v251 offset:2048
	buffer_load_dwordx4 v[104:107], v220, s[12:15], s54 offen offset:1024 sc1
	ds_read_b64_tr_b16 v[210:211], v251 offset:3072
	buffer_load_dwordx4 v[112:115], v220, s[12:15], s54 offen offset:3072 sc1
	v_mfma_f32_32x32x16_bf16 v[20:35], v[196:199], v[184:187], v[20:35]
	v_xor_b32 v226, v224, v223
	v_lshlrev_b32 v226, 4, v226
	v_and_b32 v222, 1, v222
	v_lshl_add_u32 v224, v222, 5, v224
	v_lshl_add_u32 v226, v224, 8, v226
	v_xor_b32 v235, 16, v225
	v_mfma_f32_32x32x16_bf16 v[52:67], v[200:203], v[184:187], v[52:67]
	v_xor_b32 v236, 16, v226
	s_waitcnt vmcnt(14) lgkmcnt(0)
	v_mfma_f32_32x32x16_bf16 v[4:19], v[204:207], v[188:191], v[4:19]
	ds_read_b64_tr_b16 v[116:117], v250 offset:4096
	ds_read_b64_tr_b16 v[118:119], v250 offset:5120
	ds_read_b64_tr_b16 v[120:121], v251 offset:4096
	ds_read_b64_tr_b16 v[122:123], v251 offset:5120
	ds_read_b64_tr_b16 v[124:125], v250 offset:6144
	ds_read_b64_tr_b16 v[126:127], v250 offset:7168
	v_mfma_f32_32x32x16_bf16 v[36:51], v[208:211], v[188:191], v[36:51]
	ds_read_b64_tr_b16 v[128:129], v251 offset:6144
	ds_read_b64_tr_b16 v[130:131], v251 offset:7168
	v_mfma_f32_32x32x16_bf16 v[20:35], v[204:207], v[192:195], v[20:35]
	v_mfma_f32_32x32x16_bf16 v[52:67], v[208:211], v[192:195], v[52:67]
	s_waitcnt vmcnt(12) lgkmcnt(0)
	v_mfma_f32_32x32x16_bf16 v[4:19], v[116:119], v[68:71], v[4:19]
	ds_read_b64_tr_b16 v[132:133], v250 offset:8192
	ds_read_b64_tr_b16 v[134:135], v250 offset:9216
	ds_read_b64_tr_b16 v[136:137], v251 offset:8192
	ds_read_b64_tr_b16 v[138:139], v251 offset:9216
	ds_read_b64_tr_b16 v[140:141], v250 offset:10240
	ds_read_b64_tr_b16 v[142:143], v250 offset:11264
	v_mfma_f32_32x32x16_bf16 v[36:51], v[120:123], v[68:71], v[36:51]
	ds_read_b64_tr_b16 v[144:145], v251 offset:10240
	ds_read_b64_tr_b16 v[146:147], v251 offset:11264
	v_mfma_f32_32x32x16_bf16 v[4:19], v[124:127], v[76:79], v[4:19]
	v_mfma_f32_32x32x16_bf16 v[36:51], v[128:131], v[76:79], v[36:51]
	s_waitcnt vmcnt(10) lgkmcnt(0)
	v_mfma_f32_32x32x16_bf16 v[4:19], v[132:135], v[84:87], v[4:19]
	ds_read_b64_tr_b16 v[148:149], v250 offset:12288
	ds_read_b64_tr_b16 v[150:151], v250 offset:13312
	ds_read_b64_tr_b16 v[152:153], v251 offset:12288
	ds_read_b64_tr_b16 v[154:155], v251 offset:13312
	ds_read_b64_tr_b16 v[156:157], v250 offset:14336
	ds_read_b64_tr_b16 v[158:159], v250 offset:15360
	v_mfma_f32_32x32x16_bf16 v[36:51], v[136:139], v[84:87], v[36:51]
	ds_read_b64_tr_b16 v[160:161], v251 offset:14336
	ds_read_b64_tr_b16 v[162:163], v251 offset:15360
	v_mfma_f32_32x32x16_bf16 v[4:19], v[140:143], v[92:95], v[4:19]
	v_mfma_f32_32x32x16_bf16 v[36:51], v[144:147], v[92:95], v[36:51]
	s_waitcnt vmcnt(8) lgkmcnt(0)
	v_mfma_f32_32x32x16_bf16 v[4:19], v[148:151], v[100:103], v[4:19]
	v_mfma_f32_32x32x16_bf16 v[36:51], v[152:155], v[100:103], v[36:51]
	v_mfma_f32_32x32x16_bf16 v[4:19], v[156:159], v[108:111], v[4:19]
	v_mfma_f32_32x32x16_bf16 v[36:51], v[160:163], v[108:111], v[36:51]
	s_waitcnt vmcnt(6)
	v_mfma_f32_32x32x16_bf16 v[20:35], v[116:119], v[72:75], v[20:35]
	v_mfma_f32_32x32x16_bf16 v[52:67], v[120:123], v[72:75], v[52:67]
	s_nop 7
	ds_write_b128 v227, v[4:7] offset:0
	ds_write_b128 v228, v[8:11] offset:0
	v_mfma_f32_32x32x16_bf16 v[20:35], v[124:127], v[80:83], v[20:35]
	v_mfma_f32_32x32x16_bf16 v[52:67], v[128:131], v[80:83], v[52:67]
	s_waitcnt vmcnt(2)
	v_mfma_f32_32x32x16_bf16 v[20:35], v[132:135], v[88:91], v[20:35]
	ds_write_b128 v229, v[12:15] offset:0
	v_lshlrev_b32 v164, 16, v212
	v_and_b32 v165, 0xffff0000, v212
	v_lshlrev_b32 v166, 16, v213
	v_mfma_f32_32x32x16_bf16 v[52:67], v[136:139], v[88:91], v[52:67]
	ds_write_b128 v230, v[16:19] offset:0
	v_and_b32 v167, 0xffff0000, v213
	v_lshlrev_b32 v168, 16, v214
	v_and_b32 v169, 0xffff0000, v214
	v_mfma_f32_32x32x16_bf16 v[20:35], v[140:143], v[96:99], v[20:35]
	ds_write_b128 v231, v[36:39] offset:0
	v_lshlrev_b32 v170, 16, v215
	v_and_b32 v171, 0xffff0000, v215
	v_mfma_f32_32x32x16_bf16 v[52:67], v[144:147], v[96:99], v[52:67]
	s_waitcnt vmcnt(0)
	v_mfma_f32_32x32x16_bf16 v[20:35], v[148:151], v[104:107], v[20:35]
	ds_write_b128 v232, v[40:43] offset:0
	v_lshlrev_b32 v172, 16, v216
	v_and_b32 v173, 0xffff0000, v216
	v_lshlrev_b32 v174, 16, v217
	v_mfma_f32_32x32x16_bf16 v[20:35], v[156:159], v[112:115], v[20:35]
	ds_write_b128 v233, v[44:47] offset:0
	v_and_b32 v175, 0xffff0000, v217
	v_lshlrev_b32 v176, 16, v218
	v_and_b32 v177, 0xffff0000, v218
	v_mfma_f32_32x32x16_bf16 v[52:67], v[152:155], v[104:107], v[52:67]
	ds_write_b128 v234, v[48:51] offset:0
	v_lshlrev_b32 v178, 16, v219
	v_and_b32 v179, 0xffff0000, v219
	v_mfma_f32_32x32x16_bf16 v[52:67], v[160:163], v[112:115], v[52:67]
	s_nop 2
	ds_write_b128 v227, v[20:23] offset:8192
	ds_write_b128 v228, v[24:27] offset:8192
	ds_write_b128 v229, v[28:31] offset:8192
	ds_write_b128 v230, v[32:35] offset:8192
	s_nop 4
	ds_write_b128 v231, v[52:55] offset:8192
	ds_write_b128 v232, v[56:59] offset:8192
	ds_write_b128 v233, v[60:63] offset:8192
	ds_write_b128 v234, v[64:67] offset:8192
L_p2_bar:
	s_waitcnt lgkmcnt(0)
	s_waitcnt lgkmcnt(0)
	s_barrier
	ds_read_b128 v[4:7], v225 offset:0
	ds_read_b128 v[12:15], v225 offset:16384
	ds_read_b128 v[20:23], v225 offset:32768
	ds_read_b128 v[28:31], v226 offset:49152
	ds_read_b128 v[8:11], v235 offset:0
	ds_read_b128 v[16:19], v235 offset:16384
	ds_read_b128 v[24:27], v235 offset:32768
	ds_read_b128 v[32:35], v236 offset:49152
	ds_read_b128 v[36:39], v225 offset:8192
	ds_read_b128 v[44:47], v225 offset:24576
	ds_read_b128 v[52:55], v225 offset:40960
	ds_read_b128 v[60:63], v226 offset:53248
	ds_read_b128 v[40:43], v235 offset:8192
	ds_read_b128 v[48:51], v235 offset:24576
	ds_read_b128 v[56:59], v235 offset:40960
	ds_read_b128 v[64:67], v236 offset:53248
	s_waitcnt lgkmcnt(14)
	v_pk_add_f32 v[4:5], v[4:5], v[12:13]
	v_pk_add_f32 v[6:7], v[6:7], v[14:15]
	s_waitcnt lgkmcnt(13)
	v_pk_add_f32 v[4:5], v[4:5], v[20:21]
	v_pk_add_f32 v[6:7], v[6:7], v[22:23]
	v_exp_f32 v12, -v4
	v_exp_f32 v13, -v5
	v_exp_f32 v14, -v6
	v_exp_f32 v15, -v7
	s_waitcnt lgkmcnt(10)
	v_pk_add_f32 v[8:9], v[8:9], v[16:17]
	v_pk_add_f32 v[10:11], v[10:11], v[18:19]
	s_waitcnt lgkmcnt(9)
	v_pk_add_f32 v[8:9], v[8:9], v[24:25]
	v_pk_add_f32 v[10:11], v[10:11], v[26:27]
	v_exp_f32 v16, -v8
	v_exp_f32 v17, -v9
	v_exp_f32 v18, -v10
	v_exp_f32 v19, -v11
	v_pk_add_f32 v[12:13], v[12:13], 1.0 op_sel_hi:[1,0]
	v_pk_add_f32 v[14:15], v[14:15], 1.0 op_sel_hi:[1,0]
	v_rcp_f32 v12, v12
	v_rcp_f32 v13, v13
	v_rcp_f32 v14, v14
	v_rcp_f32 v15, v15
	v_pk_mul_f32 v[4:5], v[4:5], v[28:29]
	v_pk_mul_f32 v[6:7], v[6:7], v[30:31]
	v_pk_add_f32 v[16:17], v[16:17], 1.0 op_sel_hi:[1,0]
	v_pk_add_f32 v[18:19], v[18:19], 1.0 op_sel_hi:[1,0]
	v_rcp_f32 v16, v16
	v_rcp_f32 v17, v17
	v_rcp_f32 v18, v18
	v_rcp_f32 v19, v19
	s_waitcnt lgkmcnt(8)
	v_pk_mul_f32 v[8:9], v[8:9], v[32:33]
	v_pk_mul_f32 v[10:11], v[10:11], v[34:35]
	v_pk_fma_f32 v[4:5], v[4:5], v[12:13], v[164:165]
	v_pk_fma_f32 v[6:7], v[6:7], v[14:15], v[166:167]
	v_pk_fma_f32 v[8:9], v[8:9], v[16:17], v[168:169]
	v_pk_fma_f32 v[10:11], v[10:11], v[18:19], v[170:171]
	v_cvt_pk_bf16_f32 v20, v4, v5
	v_cvt_pk_bf16_f32 v21, v6, v7
	v_cvt_pk_bf16_f32 v22, v8, v9
	v_cvt_pk_bf16_f32 v23, v10, v11
	s_add_u32 s47, s44, 0
	buffer_store_dwordx4 v[20:23], v221, s[24:27], s47 offen nt
	s_waitcnt lgkmcnt(6)
	v_pk_add_f32 v[36:37], v[36:37], v[44:45]
	v_pk_add_f32 v[38:39], v[38:39], v[46:47]
	s_waitcnt lgkmcnt(5)
	v_pk_add_f32 v[36:37], v[36:37], v[52:53]
	v_pk_add_f32 v[38:39], v[38:39], v[54:55]
	v_exp_f32 v44, -v36
	v_exp_f32 v45, -v37
	v_exp_f32 v46, -v38
	v_exp_f32 v47, -v39
	s_waitcnt lgkmcnt(2)
	v_pk_add_f32 v[40:41], v[40:41], v[48:49]
	v_pk_add_f32 v[42:43], v[42:43], v[50:51]
	s_waitcnt lgkmcnt(1)
	v_pk_add_f32 v[40:41], v[40:41], v[56:57]
	v_pk_add_f32 v[42:43], v[42:43], v[58:59]
	v_exp_f32 v48, -v40
	v_exp_f32 v49, -v41
	v_exp_f32 v50, -v42
	v_exp_f32 v51, -v43
	v_pk_add_f32 v[44:45], v[44:45], 1.0 op_sel_hi:[1,0]
	v_pk_add_f32 v[46:47], v[46:47], 1.0 op_sel_hi:[1,0]
	v_rcp_f32 v44, v44
	v_rcp_f32 v45, v45
	v_rcp_f32 v46, v46
	v_rcp_f32 v47, v47
	v_pk_mul_f32 v[36:37], v[36:37], v[60:61]
	v_pk_mul_f32 v[38:39], v[38:39], v[62:63]
	v_pk_add_f32 v[48:49], v[48:49], 1.0 op_sel_hi:[1,0]
	v_pk_add_f32 v[50:51], v[50:51], 1.0 op_sel_hi:[1,0]
	v_rcp_f32 v48, v48
	v_rcp_f32 v49, v49
	v_rcp_f32 v50, v50
	v_rcp_f32 v51, v51
	s_waitcnt lgkmcnt(0)
	v_pk_mul_f32 v[40:41], v[40:41], v[64:65]
	v_pk_mul_f32 v[42:43], v[42:43], v[66:67]
	v_pk_fma_f32 v[36:37], v[36:37], v[44:45], v[172:173]
	v_pk_fma_f32 v[38:39], v[38:39], v[46:47], v[174:175]
	v_pk_fma_f32 v[40:41], v[40:41], v[48:49], v[176:177]
	v_pk_fma_f32 v[42:43], v[42:43], v[50:51], v[178:179]
	v_cvt_pk_bf16_f32 v52, v36, v37
	v_cvt_pk_bf16_f32 v53, v38, v39
	v_cvt_pk_bf16_f32 v54, v40, v41
	v_cvt_pk_bf16_f32 v55, v42, v43
	s_add_u32 s47, s44, 28672
	buffer_store_dwordx4 v[52:55], v221, s[24:27], s47 offen nt
L_f_done:
	s_waitcnt vmcnt(0)
L_f_end:
	s_endpgm
L_f_attn:
	s_and_b32 s40, s32, 1
	s_lshr_b32 s41, s32, 1
	s_lshl_b32 s47, s33, 7
	s_add_u32 s47, s47, s41
	s_lshl_b32 s42, s40, 6
	s_add_u32 s42, s42, s47
	s_mul_i32 s42, s42, 896
	s_mul_i32 s44, s41, 9216
	s_lshl_b32 s43, s40, 12
	s_add_u32 s43, s43, s44
	s_add_u32 s43, s43, 1024
	s_lshl_b32 s49, s40, 9
	s_add_u32 s44, s44, s49
	s_mul_i32 s45, s32, 43008
	s_lshl_b32 s46, s32, 11
	v_lshrrev_b32 v1, 3, v0
	v_and_b32 v2, 7, v0
	v_lshrrev_b32 v3, 1, v1
	s_add_u32 s49, s41, 1
	s_and_b32 s49, s49, 1
	s_lshl_b32 s49, s49, 2
	v_add_u32 v4, s49, v3
	v_xor_b32 v4, v4, v2
	v_lshlrev_b32 v4, 4, v4
	v_mul_u32_u24 v5, 1792, v1
	v_add_u32 v7, v5, v4
	v_add_u32 v9, 26624, v7
	v_xor_b32 v4, 64, v4
	v_add_u32 v8, v5, v4
	v_add_u32 v10, 39936, v8
	v_add_u32 v8, 13312, v8
	s_lshl_b32 s49, s41, 2
	s_lshl_b32 s50, s40, 1
	s_add_u32 s49, s49, s50
	v_add_u32 v4, s49, v3
	v_and_b32 v4, 7, v4
	v_xor_b32 v4, v4, v2
	v_lshlrev_b32 v4, 4, v4
	v_add_u32 v4, v5, v4
	s_lshl_b32 s49, s33, 7
	s_add_u32 s49, s49, s41
	s_lshl_b32 s50, s40, 3
	s_add_u32 s49, s49, s50
	s_sub_u32 s49, s49, 16
	s_mul_i32 s49, s49, 896
	v_add_u32 v11, s49, v4
	v_and_b32 v3, 1, v3
	v_lshlrev_b32 v3, 1, v3
	v_xor_b32 v3, v3, v2
	v_mul_u32_u24 v5, 2688, v1
	s_mul_i32 s49, s34, 112
	v_add_u32 v5, s49, v5
	v_mov_b32 v6, 0x40000000
	v_lshl_add_u32 v12, v3, 4, v5
	v_cmp_eq_u32 vcc, 7, v3
	s_nop 1
	v_cndmask_b32 v12, v12, v6, vcc
	v_xor_b32 v3, 4, v3
	v_lshl_add_u32 v13, v3, 4, v5
	v_add_u32 v13, 20480, v13
	v_cmp_eq_u32 vcc, 7, v3
	s_nop 1
	v_cndmask_b32 v13, v13, v6, vcc
	s_mov_b32 s60, 0xdfdf7f7f
	s_mov_b32 s61, 0xdfdf7f7f
	s_mov_b32 s62, 0xfdfdf7f7
	s_mov_b32 s63, 0xfdfdf7f7
	s_and_b32 s49, s3, 7
	s_sub_u32 s50, s49, 7
	s_cmp_ge_u32 s49, 7
	s_cselect_b32 s49, s50, s49
	s_lshl_b32 s84, s49, 7
	s_mul_i32 s91, s84, 1344
	s_add_u32 s91, s91, s45
	s_mov_b32 s6, 0x1c0000
	s_mov_b32 s7, 0x20000
	s_mov_b32 s10, 0x126000
	s_mov_b32 s11, 0x20000
	s_waitcnt lgkmcnt(0)
	s_mov_b32 s4, s64
	s_mov_b32 s5, s65
	s_mov_b32 s8, s66
	s_mov_b32 s9, s67
	s_add_u32 m0, s43, 0
	s_add_u32 s47, s42, s84
	buffer_load_dwordx4 v7, s[4:7], s47 offen offset:0 lds
	buffer_load_dwordx4 v8, s[4:7], s47 offen offset:1024 lds
	buffer_load_dwordx4 v9, s[4:7], s47 offen offset:2048 lds
	buffer_load_dwordx4 v10, s[4:7], s47 offen offset:3072 lds
	s_add_u32 m0, s44, 0
	s_mov_b32 exec_hi, 0
	buffer_load_dwordx4 v11, s[4:7], s84 offen lds
	s_mov_b32 exec_hi, -1
	s_add_u32 m0, s46, 55680
	s_nop 0
	buffer_load_dwordx4 v12, s[8:11], s91 offen offset:0 lds
	buffer_load_dwordx4 v13, s[8:11], s91 offen offset:1024 lds
	s_add_u32 m0, s46, 63872
	s_add_u32 s47, s91, 896
	buffer_load_dwordx4 v12, s[8:11], s47 offen offset:0 lds
	buffer_load_dwordx4 v13, s[8:11], s47 offen offset:1024 lds
	s_add_u32 m0, s46, 72064
	s_add_u32 s47, s91, 1792
	s_mov_b64 exec, s[60:61]
	buffer_load_dwordx4 v12, s[8:11], s47 offen offset:0 lds
	s_mov_b64 exec, -1
	s_mov_b64 exec, s[62:63]
	buffer_load_dwordx4 v13, s[8:11], s47 offen offset:1024 lds
	s_mov_b64 exec, -1
	s_mov_b32 s12, s82
	s_mov_b32 s13, s83
	s_mov_b32 s14, 0xa11000
	s_mov_b32 s15, 0x20000
	s_cmp_eq_u32 s2, 255
	s_cselect_b32 s49, s32, 0
	s_cmp_lg_u32 s49, 3
	s_cbranch_scc1 L_noinit
	v_mul_u32_u24 v3, 4352, v0
	v_add_u32 v3, 10485760, v3
	v_mov_b32 v243, 0
	s_mov_b64 exec, 0xffff
	buffer_store_dword v243, v3, s[12:15], 0 offen offset:0 sc1
	buffer_store_dword v243, v3, s[12:15], 0 offen offset:256 sc1
	buffer_store_dword v243, v3, s[12:15], 0 offen offset:512 sc1
	s_mov_b64 exec, -1
L_noinit:
	s_add_u32 s85, s84, 128
	s_cmp_eq_u32 s85, 896
	s_cselect_b32 s85, 0, s85
	s_mul_i32 s92, s85, 1344
	s_add_u32 s92, s92, s45
	s_add_u32 s86, s85, 128
	s_cmp_eq_u32 s86, 896
	s_cselect_b32 s86, 0, s86
	s_mul_i32 s93, s86, 1344
	s_add_u32 s93, s93, s45
	s_mov_b32 s12, s82
	s_mov_b32 s13, s83
	s_mov_b32 s14, 0xa11000
	s_mov_b32 s15, 0x20000
	s_mov_b32 s16, s76
	s_mov_b32 s17, s77
	s_mov_b32 s18, 0x188000
	s_mov_b32 s19, 0x20000
	s_mov_b32 s20, s68
	s_mov_b32 s21, s69
	s_mov_b32 s22, 0x62000
	s_mov_b32 s23, 0x20000
	s_mov_b32 s24, s78
	s_mov_b32 s25, s79
	s_mov_b32 s26, 0x1c0000
	s_mov_b32 s27, 0x20000
	s_mov_b32 s38, s80
	s_mov_b32 s39, s81
	s_mul_i32 s49, s3, 37
	s_lshr_b32 s49, s49, 8
	s_mul_i32 s50, s49, 7
	s_sub_u32 s36, s3, s50
	s_and_b32 s50, s2, 7
	s_lshr_b32 s35, s50, 1
	s_and_b32 s50, s50, 1
	s_xor_b32 s50, s50, 1
	s_lshl_b32 s50, s50, 2
	s_add_u32 s35, s35, s50
	s_lshl_b32 s35, s35, 2
	s_add_u32 s35, s35, s49
	s_lshl_b32 s83, s36, 7
	s_cmp_ge_u32 s3, 28
	s_cselect_b32 s83, 0x7f000000, s83
	s_mul_i32 s73, s32, 57344
	s_mov_b32 s18, 1605632
	s_mov_b32 s72, 200704
	s_mov_b32 s74, 28672
	s_mov_b32 s75, 28672
	s_cmp_eq_u32 s32, 3
	s_cselect_b32 s16, s20, s16
	s_cselect_b32 s17, s21, s17
	s_cselect_b32 s18, 401408, s18
	s_cselect_b32 s72, 50176, s72
	s_cselect_b32 s73, 0, s73
	s_cselect_b32 s74, 25088, s74
	s_cselect_b32 s75, 0, s75
	s_add_u32 s73, s73, s83
	s_add_u32 s76, s74, s75
	s_add_u32 s87, s86, 128
	s_cmp_eq_u32 s87, 896
	s_cselect_b32 s87, 0, s87
	s_mul_i32 s94, s87, 1344
	s_add_u32 s94, s94, s45
	s_add_u32 s88, s87, 128
	s_cmp_eq_u32 s88, 896
	s_cselect_b32 s88, 0, s88
	s_mul_i32 s95, s88, 1344
	s_add_u32 s95, s95, s45
	s_add_u32 s74, s74, s73
	s_add_u32 s75, s75, s73
	s_add_u32 s76, s76, s73
	s_lshl_b32 s82, s32, 3
	s_or_b32 s82, s82, 0x80000
	s_bfe_u32 s77, 0xff140706, s82
	s_cmp_eq_u32 s77, 255
	s_cselect_b32 s77, 16384, s77
	s_bfe_u32 s78, 0xff232215, s82
	s_cmp_eq_u32 s78, 255
	s_cselect_b32 s78, 16384, s78
	s_bfe_u32 s79, 0xffff3130, s82
	s_cmp_eq_u32 s79, 255
	s_cselect_b32 s79, 16384, s79
	s_lshl_b32 s80, s32, 12
	s_add_u32 s80, s80, 65536
	s_lshl_b32 s81, s32, 14
	s_mov_b32 s20, s38
	s_mov_b32 s21, s39
	s_mov_b32 s22, 0x100
	s_mov_b32 s23, 0x20000
	s_mul_i32 s82, s33, 4352
	s_add_u32 s82, s82, 10485760
	v_mov_b32 v240, 2.0
	v_writelane_b32 v240, s82, 0
	s_lshr_b32 s82, s35, 1
	s_mul_i32 s82, s82, 4352
	s_add_u32 s82, s82, 10485760
	v_mov_b32 v241, 2.0
	v_writelane_b32 v241, s82, 0
	s_cmp_eq_u32 s32, 3
	s_cselect_b32 s82, 512, 0
	v_add_u32 v241, s82, v241
	v_mov_b32 v16, 0
	v_mov_b32 v20, 0x3f803f80
	v_mov_b32 v17, 0
	v_mov_b32 v21, 0x3f803f80
	v_mov_b32 v18, 0
	v_mov_b32 v22, 0x3f803f80
	v_mov_b32 v19, 0
	v_mov_b32 v23, 0x3f803f80
	v_lshrrev_b32 v3, 1, v0
	v_and_b32 v3, 1, v3
	v_lshrrev_b32 v4, 3, v0
	s_add_u32 s89, s88, 128
	s_cmp_eq_u32 s89, 896
	s_cselect_b32 s89, 0, s89
	s_mul_i32 s96, s89, 1344
	s_add_u32 s96, s96, s45
	s_add_u32 s90, s89, 128
	s_cmp_eq_u32 s90, 896
	s_cselect_b32 s90, 0, s90
	s_mul_i32 s97, s90, 1344
	s_add_u32 s97, s97, s45
	v_and_b32 v4, 1, v4
	v_lshl_or_b32 v3, v4, 1, v3
	v_lshlrev_b32 v3, 1, v3
	v_xor_b32 v3, 7, v3
	v_lshlrev_b32 v3, 4, v3
	s_add_u32 m0, s43, 18560
	v_lshl_add_u32 v3, v0, 7, v3
	v_add_u32 v3, 55680, v3
	v_add_u32 v4, 49152, v3
	ds_write_b128 v3, v[20:23] offset:16384
	ds_write_b128 v3, v[20:23] offset:40960
	ds_write_b128 v4, v[20:23] offset:16384
	v_and_b32 v5, 7, v0
	v_lshlrev_b32 v5, 4, v5
	ds_write_b128 v5, v[20:23] offset:18432
	ds_write_b128 v5, v[20:23] offset:36992
	ds_write_b128 v5, v[20:23] offset:55552
	v_and_b32 v24, 15, v0
	v_lshrrev_b32 v25, 4, v0
	s_add_u32 s47, s42, s85
	s_lshl_b32 s49, s41, 2
	s_add_u32 s50, s49, 4
	v_lshrrev_b32 v3, 1, v24
	v_add_u32 v4, s50, v3
	v_and_b32 v4, 7, v4
	v_xor_b32 v4, v4, v25
	v_lshlrev_b32 v4, 4, v4
	s_mul_i32 s51, s41, 9216
	s_add_u32 s52, s51, 1024
	v_lshl_add_u32 v5, v24, 7, s52
	v_add_u32 v26, v5, v4
	v_xor_b32 v4, 64, v4
	v_add_u32 v27, v5, v4
	v_subrev_u32 v3, 8, v24
	buffer_load_dwordx4 v7, s[4:7], s47 offen offset:0 lds
	v_lshrrev_b32 v4, 1, v3
	v_add_u32 v4, s49, v4
	v_and_b32 v4, 7, v4
	v_xor_b32 v4, v4, v25
	v_lshlrev_b32 v4, 4, v4
	v_lshl_add_u32 v5, v3, 7, s51
	v_mov_b32 v6, 18432
	v_cmp_gt_u32 vcc, 8, v24
	s_nop 1
	v_cndmask_b32 v5, v5, v6, vcc
	v_add_u32 v28, v5, v4
	v_xor_b32 v4, 64, v4
	v_add_u32 v29, v5, v4
	v_lshrrev_b32 v6, 2, v24
	buffer_load_dwordx4 v8, s[4:7], s47 offen offset:1024 lds
	v_and_b32 v34, 3, v24
	v_lshrrev_b32 v3, 1, v6
	v_and_b32 v4, 1, v25
	v_lshl_or_b32 v3, v4, 1, v3
	v_lshlrev_b32 v3, 5, v3
	v_lshl_add_u32 v4, v25, 3, v6
	v_lshlrev_b32 v4, 7, v4
	v_add_u32 v4, 55680, v4
	s_mul_i32 s49, s40, 56
	s_add_u32 s50, s49, 0
	v_lshl_add_u32 v5, v34, 3, s50
	v_xor_b32 v5, v5, v3
	v_add_u32 v30, v4, v5
	v_add_u32 v32, 49152, v30
	buffer_load_dwordx4 v9, s[4:7], s47 offen offset:2048 lds
	s_add_u32 s50, s49, 32
	v_lshl_add_u32 v5, v34, 3, s50
	s_lshl_b32 s51, s40, 3
	s_sub_u32 s51, 120, s51
	v_mov_b32 v31, s51
	v_cmp_eq_u32 vcc, 3, v34
	s_nop 1
	v_cndmask_b32 v5, v5, v31, vcc
	v_xor_b32 v5, v5, v3
	v_add_u32 v31, v4, v5
	v_add_u32 v33, 49152, v31
	v_lshrrev_b32 v3, 3, v0
	v_and_b32 v4, 7, v0
	v_lshrrev_b32 v5, 1, v3
	v_and_b32 v5, 1, v5
	buffer_load_dwordx4 v10, s[4:7], s47 offen offset:3072 lds
	v_lshlrev_b32 v5, 2, v5
	v_xor_b32 v4, v4, v5
	v_lshlrev_b32 v4, 4, v4
	v_mul_u32_u24 v3, 896, v3
	v_add_u32 v244, v3, v4
	v_add_u32 v245, 6144, v244
	v_add_u32 v246, 12288, v244
	v_add_u32 v247, 18432, v244
	v_and_b32 v3, 15, v0
	v_lshrrev_b32 v3, 2, v3
	v_lshrrev_b32 v4, 5, v0
	v_lshl_add_u32 v4, v4, 2, v3
	v_lshlrev_b32 v4, 7, v4
	s_add_u32 m0, s44, 18560
	v_lshrrev_b32 v3, 1, v3
	v_lshl_or_b32 v4, v3, 6, v4
	v_lshrrev_b32 v3, 4, v0
	v_and_b32 v3, 1, v3
	v_lshl_or_b32 v4, v3, 5, v4
	v_and_b32 v3, 3, v0
	v_lshl_or_b32 v4, v3, 3, v4
	v_add_u32 v248, s80, v4
	v_xor_b32 v4, 64, v4
	v_add_u32 v249, s80, v4
	v_and_b32 v3, 15, v0
	v_lshrrev_b32 v3, 2, v3
	v_lshrrev_b32 v4, 5, v0
	v_lshl_add_u32 v4, v4, 2, v3
	s_mov_b32 exec_hi, 0
	buffer_load_dwordx4 v11, s[4:7], s85 offen lds
	s_mov_b32 exec_hi, -1
	v_lshlrev_b32 v4, 7, v4
	v_lshrrev_b32 v3, 1, v3
	v_lshl_or_b32 v4, v3, 6, v4
	v_lshrrev_b32 v3, 4, v0
	v_and_b32 v3, 1, v3
	v_lshl_or_b32 v4, v3, 5, v4
	v_and_b32 v3, 3, v0
	v_lshl_or_b32 v4, v3, 3, v4
	v_add_u32 v250, s81, v4
	v_xor_b32 v4, 64, v4
	v_add_u32 v251, s81, v4
	v_add_u32 v252, 70656, v248
	v_add_u32 v253, 70656, v249
	s_waitcnt vmcnt(5)
	s_waitcnt lgkmcnt(0)
	s_barrier
	ds_read_b128 v[176:179], v28 offset:0
	ds_read_b64_tr_b16 a[32:33], v30 offset:0
	ds_read_b64_tr_b16 a[34:35], v30 offset:512
	ds_read_b128 a[0:3], v26 offset:0
	ds_read_b128 a[4:7], v26 offset:2048
	ds_read_b128 a[8:11], v26 offset:4096
	ds_read_b128 a[12:15], v26 offset:6144
	ds_read_b64_tr_b16 a[36:37], v31 offset:0
	ds_read_b64_tr_b16 a[38:39], v31 offset:512
	ds_read_b64_tr_b16 a[40:41], v30 offset:8192
	ds_read_b64_tr_b16 a[42:43], v30 offset:8704
	ds_read_b64_tr_b16 a[44:45], v31 offset:8192
	ds_read_b64_tr_b16 a[46:47], v31 offset:8704
	ds_read_b64_tr_b16 a[48:49], v30 offset:16384
	ds_read_b64_tr_b16 a[50:51], v30 offset:16896
	ds_read_b64_tr_b16 a[52:53], v31 offset:16384
	ds_read_b64_tr_b16 a[54:55], v31 offset:16896
	s_waitcnt lgkmcnt(0)
	v_mfma_f32_16x16x32_bf16 v[36:39], a[32:35], v[176:179], 0
	s_add_u32 m0, s46, 80256
	ds_read_b128 v[180:183], v29 offset:0
	v_mfma_f32_16x16x32_bf16 v[44:47], a[32:35], a[0:3], 0
	ds_read_b64_tr_b16 a[56:57], v30 offset:4096
	v_mfma_f32_16x16x32_bf16 v[52:55], a[32:35], a[4:7], 0
	buffer_load_dwordx4 v12, s[8:11], s92 offen offset:0 lds
	v_mfma_f32_16x16x32_bf16 v[60:63], a[32:35], a[8:11], 0
	ds_read_b64_tr_b16 a[58:59], v30 offset:4608
	v_mfma_f32_16x16x32_bf16 v[68:71], a[32:35], a[12:15], 0
	ds_read_b128 a[16:19], v27 offset:0
	v_mfma_f32_16x16x32_bf16 v[40:43], a[36:39], v[176:179], 0
	buffer_load_dwordx4 v13, s[8:11], s92 offen offset:1024 lds
	v_mfma_f32_16x16x32_bf16 v[48:51], a[36:39], a[0:3], 0
	v_mfma_f32_16x16x32_bf16 v[56:59], a[36:39], a[4:7], 0
	ds_read_b128 a[20:23], v27 offset:2048
	s_add_u32 m0, s46, 88448
	v_mfma_f32_16x16x32_bf16 v[64:67], a[36:39], a[8:11], 0
	ds_read_b128 a[24:27], v27 offset:4096
	s_add_u32 s47, s92, 896
	v_mfma_f32_16x16x32_bf16 v[72:75], a[36:39], a[12:15], 0
	ds_read_b128 a[28:31], v27 offset:6144
	ds_read_b64_tr_b16 a[60:61], v31 offset:4096
	v_mfma_f32_16x16x32_bf16 v[156:159], v[176:179], v[176:179], 0
	buffer_load_dwordx4 v12, s[8:11], s47 offen offset:0 lds
	v_mfma_f32_16x16x32_bf16 v[160:163], a[0:3], a[0:3], 0
	v_mfma_f32_16x16x32_bf16 v[164:167], a[4:7], a[4:7], 0
	ds_read_b64_tr_b16 a[62:63], v31 offset:4608
	v_mfma_f32_16x16x32_bf16 v[168:171], a[8:11], a[8:11], 0
	ds_read_b64_tr_b16 a[64:65], v30 offset:12288
	v_mfma_f32_16x16x32_bf16 v[172:175], a[12:15], a[12:15], 0
	buffer_load_dwordx4 v13, s[8:11], s47 offen offset:1024 lds
	v_mfma_f32_16x16x32_bf16 v[76:79], a[40:43], v[176:179], 0
	ds_read_b64_tr_b16 a[66:67], v30 offset:12800
	s_add_u32 m0, s46, 96640
	v_mfma_f32_16x16x32_bf16 v[84:87], a[40:43], a[0:3], 0
	ds_read_b64_tr_b16 a[68:69], v31 offset:12288
	s_add_u32 s47, s92, 1792
	v_mfma_f32_16x16x32_bf16 v[92:95], a[40:43], a[4:7], 0
	ds_read_b64_tr_b16 a[70:71], v31 offset:12800
	v_mfma_f32_16x16x32_bf16 v[100:103], a[40:43], a[8:11], 0
	ds_read_b64_tr_b16 a[72:73], v30 offset:20480
	v_mfma_f32_16x16x32_bf16 v[108:111], a[40:43], a[12:15], 0
	s_mov_b64 exec, s[60:61]
	buffer_load_dwordx4 v12, s[8:11], s47 offen offset:0 lds
	s_mov_b64 exec, -1
	v_mfma_f32_16x16x32_bf16 v[80:83], a[44:47], v[176:179], 0
	v_mfma_f32_16x16x32_bf16 v[88:91], a[44:47], a[0:3], 0
	ds_read_b64_tr_b16 a[74:75], v30 offset:20992
	v_mfma_f32_16x16x32_bf16 v[96:99], a[44:47], a[4:7], 0
	ds_read_b64_tr_b16 a[76:77], v31 offset:20480
	ds_read_b64_tr_b16 a[78:79], v31 offset:20992
	v_mfma_f32_16x16x32_bf16 v[104:107], a[44:47], a[8:11], 0
	s_mov_b64 exec, s[62:63]
	buffer_load_dwordx4 v13, s[8:11], s47 offen offset:1024 lds
	s_mov_b64 exec, -1
	v_mfma_f32_16x16x32_bf16 v[112:115], a[44:47], a[12:15], 0
	v_mfma_f32_16x16x32_bf16 v[116:119], v[176:179], a[48:51], 0
	v_mfma_f32_16x16x32_bf16 v[124:127], a[0:3], a[48:51], 0
	v_mfma_f32_16x16x32_bf16 v[132:135], a[4:7], a[48:51], 0
	v_mfma_f32_16x16x32_bf16 v[140:143], a[8:11], a[48:51], 0
	v_mfma_f32_16x16x32_bf16 v[148:151], a[12:15], a[48:51], 0
	v_mfma_f32_16x16x32_bf16 v[120:123], v[176:179], a[52:55], 0
	v_mfma_f32_16x16x32_bf16 v[128:131], a[0:3], a[52:55], 0
	v_mfma_f32_16x16x32_bf16 v[136:139], a[4:7], a[52:55], 0
	v_mfma_f32_16x16x32_bf16 v[144:147], a[8:11], a[52:55], 0
	v_mfma_f32_16x16x32_bf16 v[152:155], a[12:15], a[52:55], 0
	s_waitcnt vmcnt(0)
	s_waitcnt lgkmcnt(0)
	s_barrier
	s_cmp_eq_u32 s2, 255
	s_cselect_b32 s49, s32, 0
	s_cmp_lg_u32 s49, 3
	s_cbranch_scc1 L_noready
	v_mov_b32 v243, 1
	s_mov_b64 exec, 1
	buffer_store_dword v243, off, s[20:23], 0 sc1
	s_mov_b64 exec, -1
L_noready:
	v_mfma_f32_16x16x32_bf16 v[36:39], a[56:59], v[180:183], v[36:39]
	s_add_u32 m0, s43, 37120
	ds_read_b128 v[176:179], v28 offset:18560
	s_add_u32 s47, s42, s86
	v_mfma_f32_16x16x32_bf16 v[44:47], a[56:59], a[16:19], v[44:47]
	ds_read_b64_tr_b16 a[32:33], v30 offset:24576
	v_mfma_f32_16x16x32_bf16 v[52:55], a[56:59], a[20:23], v[52:55]
	buffer_load_dwordx4 v7, s[4:7], s47 offen offset:0 lds
	v_mfma_f32_16x16x32_bf16 v[60:63], a[56:59], a[24:27], v[60:63]
	v_mfma_f32_16x16x32_bf16 v[68:71], a[56:59], a[28:31], v[68:71]
	ds_read_b64_tr_b16 a[34:35], v30 offset:25088
	v_mfma_f32_16x16x32_bf16 v[40:43], a[60:63], v[180:183], v[40:43]
	buffer_load_dwordx4 v8, s[4:7], s47 offen offset:1024 lds
	v_mfma_f32_16x16x32_bf16 v[48:51], a[60:63], a[16:19], v[48:51]
	ds_read_b128 a[0:3], v26 offset:18560
	v_mfma_f32_16x16x32_bf16 v[56:59], a[60:63], a[20:23], v[56:59]
	buffer_load_dwordx4 v9, s[4:7], s47 offen offset:2048 lds
	v_mfma_f32_16x16x32_bf16 v[64:67], a[60:63], a[24:27], v[64:67]
	v_mfma_f32_16x16x32_bf16 v[72:75], a[60:63], a[28:31], v[72:75]
	ds_read_b128 a[4:7], v26 offset:20608
	v_mfma_f32_16x16x32_bf16 v[156:159], v[180:183], v[180:183], v[156:159]
	buffer_load_dwordx4 v10, s[4:7], s47 offen offset:3072 lds
	v_mfma_f32_16x16x32_bf16 v[160:163], a[16:19], a[16:19], v[160:163]
	ds_read_b128 a[8:11], v26 offset:22656
	s_add_u32 m0, s44, 37120
	v_mfma_f32_16x16x32_bf16 v[164:167], a[20:23], a[20:23], v[164:167]
	ds_read_b128 a[12:15], v26 offset:24704
	v_mfma_f32_16x16x32_bf16 v[168:171], a[24:27], a[24:27], v[168:171]
	s_mov_b32 exec_hi, 0
	buffer_load_dwordx4 v11, s[4:7], s86 offen lds
	s_mov_b32 exec_hi, -1
	v_mfma_f32_16x16x32_bf16 v[172:175], a[28:31], a[28:31], v[172:175]
	v_mfma_f32_16x16x32_bf16 v[76:79], a[64:67], v[180:183], v[76:79]
	ds_read_b64_tr_b16 a[36:37], v31 offset:24576
	v_mfma_f32_16x16x32_bf16 v[84:87], a[64:67], a[16:19], v[84:87]
	ds_read_b64_tr_b16 a[38:39], v31 offset:25088
	s_add_u32 m0, s46, 104832
	v_mfma_f32_16x16x32_bf16 v[92:95], a[64:67], a[20:23], v[92:95]
	ds_read_b64_tr_b16 a[40:41], v30 offset:32768
	v_mfma_f32_16x16x32_bf16 v[100:103], a[64:67], a[24:27], v[100:103]
	buffer_load_dwordx4 v12, s[8:11], s93 offen offset:0 lds
	v_mfma_f32_16x16x32_bf16 v[108:111], a[64:67], a[28:31], v[108:111]
	ds_read_b64_tr_b16 a[42:43], v30 offset:33280
	v_mfma_f32_16x16x32_bf16 v[80:83], a[68:71], v[180:183], v[80:83]
	buffer_load_dwordx4 v13, s[8:11], s93 offen offset:1024 lds
	v_mfma_f32_16x16x32_bf16 v[88:91], a[68:71], a[16:19], v[88:91]
	s_add_u32 m0, s46, 113024
	v_mfma_f32_16x16x32_bf16 v[96:99], a[68:71], a[20:23], v[96:99]
	ds_read_b64_tr_b16 a[44:45], v31 offset:32768
	s_add_u32 s47, s93, 896
	v_mfma_f32_16x16x32_bf16 v[104:107], a[68:71], a[24:27], v[104:107]
	ds_read_b64_tr_b16 a[46:47], v31 offset:33280
	v_mfma_f32_16x16x32_bf16 v[112:115], a[68:71], a[28:31], v[112:115]
	buffer_load_dwordx4 v12, s[8:11], s47 offen offset:0 lds
	v_mfma_f32_16x16x32_bf16 v[116:119], v[180:183], a[72:75], v[116:119]
	ds_read_b64_tr_b16 a[48:49], v30 offset:40960
	v_mfma_f32_16x16x32_bf16 v[124:127], a[16:19], a[72:75], v[124:127]
	buffer_load_dwordx4 v13, s[8:11], s47 offen offset:1024 lds
	v_mfma_f32_16x16x32_bf16 v[132:135], a[20:23], a[72:75], v[132:135]
	v_mfma_f32_16x16x32_bf16 v[140:143], a[24:27], a[72:75], v[140:143]
	ds_read_b64_tr_b16 a[50:51], v30 offset:41472
	s_add_u32 m0, s46, 121216
	s_add_u32 s47, s93, 1792
	v_mfma_f32_16x16x32_bf16 v[148:151], a[28:31], a[72:75], v[148:151]
	ds_read_b64_tr_b16 a[52:53], v31 offset:40960
	v_mfma_f32_16x16x32_bf16 v[120:123], v[180:183], a[76:79], v[120:123]
	ds_read_b64_tr_b16 a[54:55], v31 offset:41472
	v_mfma_f32_16x16x32_bf16 v[128:131], a[16:19], a[76:79], v[128:131]
	s_mov_b64 exec, s[60:61]
	buffer_load_dwordx4 v12, s[8:11], s47 offen offset:0 lds
	s_mov_b64 exec, -1
	v_mfma_f32_16x16x32_bf16 v[136:139], a[20:23], a[76:79], v[136:139]
	v_mfma_f32_16x16x32_bf16 v[144:147], a[24:27], a[76:79], v[144:147]
	s_mov_b64 exec, s[62:63]
	buffer_load_dwordx4 v13, s[8:11], s47 offen offset:1024 lds
	s_mov_b64 exec, -1
	v_mfma_f32_16x16x32_bf16 v[152:155], a[28:31], a[76:79], v[152:155]
	s_waitcnt lgkmcnt(0)
	v_mfma_f32_16x16x32_bf16 v[36:39], a[32:35], v[176:179], v[36:39]
	ds_read_b128 v[180:183], v29 offset:18560
	s_add_u32 m0, s43, 0
	v_mfma_f32_16x16x32_bf16 v[44:47], a[32:35], a[0:3], v[44:47]
	ds_read_b64_tr_b16 a[56:57], v30 offset:28672
	s_add_u32 s47, s42, s87
	v_mfma_f32_16x16x32_bf16 v[52:55], a[32:35], a[4:7], v[52:55]
	ds_read_b64_tr_b16 a[58:59], v30 offset:29184
	v_mfma_f32_16x16x32_bf16 v[60:63], a[32:35], a[8:11], v[60:63]
	buffer_load_dwordx4 v7, s[4:7], s47 offen offset:0 lds
	v_mfma_f32_16x16x32_bf16 v[68:71], a[32:35], a[12:15], v[68:71]
	ds_read_b128 a[16:19], v27 offset:18560
	v_mfma_f32_16x16x32_bf16 v[40:43], a[36:39], v[176:179], v[40:43]
	ds_read_b128 a[20:23], v27 offset:20608
	v_mfma_f32_16x16x32_bf16 v[48:51], a[36:39], a[0:3], v[48:51]
	ds_read_b128 a[24:27], v27 offset:22656
	v_mfma_f32_16x16x32_bf16 v[56:59], a[36:39], a[4:7], v[56:59]
	buffer_load_dwordx4 v8, s[4:7], s47 offen offset:1024 lds
	v_mfma_f32_16x16x32_bf16 v[64:67], a[36:39], a[8:11], v[64:67]
	ds_read_b128 a[28:31], v27 offset:24704
	v_mfma_f32_16x16x32_bf16 v[72:75], a[36:39], a[12:15], v[72:75]
	ds_read_b64_tr_b16 a[60:61], v31 offset:28672
	v_mfma_f32_16x16x32_bf16 v[156:159], v[176:179], v[176:179], v[156:159]
	buffer_load_dwordx4 v9, s[4:7], s47 offen offset:2048 lds
	v_mfma_f32_16x16x32_bf16 v[160:163], a[0:3], a[0:3], v[160:163]
	v_mfma_f32_16x16x32_bf16 v[164:167], a[4:7], a[4:7], v[164:167]
	ds_read_b64_tr_b16 a[62:63], v31 offset:29184
	ds_read_b64_tr_b16 a[64:65], v30 offset:36864
	v_mfma_f32_16x16x32_bf16 v[168:171], a[8:11], a[8:11], v[168:171]
	buffer_load_dwordx4 v10, s[4:7], s47 offen offset:3072 lds
	v_mfma_f32_16x16x32_bf16 v[172:175], a[12:15], a[12:15], v[172:175]
	v_mfma_f32_16x16x32_bf16 v[76:79], a[40:43], v[176:179], v[76:79]
	ds_read_b64_tr_b16 a[66:67], v30 offset:37376
	v_mfma_f32_16x16x32_bf16 v[84:87], a[40:43], a[0:3], v[84:87]
	ds_read_b64_tr_b16 a[68:69], v31 offset:36864
	s_add_u32 m0, s44, 0
	v_mfma_f32_16x16x32_bf16 v[92:95], a[40:43], a[4:7], v[92:95]
	ds_read_b64_tr_b16 a[70:71], v31 offset:37376
	ds_read_b64_tr_b16 a[72:73], v30 offset:45056
	v_mfma_f32_16x16x32_bf16 v[100:103], a[40:43], a[8:11], v[100:103]
	ds_read_b64_tr_b16 a[74:75], v30 offset:45568
	v_mfma_f32_16x16x32_bf16 v[108:111], a[40:43], a[12:15], v[108:111]
	s_mov_b32 exec_hi, 0
	buffer_load_dwordx4 v11, s[4:7], s87 offen lds
	s_mov_b32 exec_hi, -1
	v_mfma_f32_16x16x32_bf16 v[80:83], a[44:47], v[176:179], v[80:83]
	v_mfma_f32_16x16x32_bf16 v[88:91], a[44:47], a[0:3], v[88:91]
	ds_read_b64_tr_b16 a[76:77], v31 offset:45056
	v_mfma_f32_16x16x32_bf16 v[96:99], a[44:47], a[4:7], v[96:99]
	ds_read_b64_tr_b16 a[78:79], v31 offset:45568
	s_add_u32 m0, s46, 55680
	v_mfma_f32_16x16x32_bf16 v[104:107], a[44:47], a[8:11], v[104:107]
	buffer_load_dwordx4 v12, s[8:11], s94 offen offset:0 lds
	v_mfma_f32_16x16x32_bf16 v[112:115], a[44:47], a[12:15], v[112:115]
	v_mfma_f32_16x16x32_bf16 v[116:119], v[176:179], a[48:51], v[116:119]
	v_mfma_f32_16x16x32_bf16 v[124:127], a[0:3], a[48:51], v[124:127]
	v_mfma_f32_16x16x32_bf16 v[132:135], a[4:7], a[48:51], v[132:135]
	v_mfma_f32_16x16x32_bf16 v[140:143], a[8:11], a[48:51], v[140:143]
	v_mfma_f32_16x16x32_bf16 v[148:151], a[12:15], a[48:51], v[148:151]
	v_mfma_f32_16x16x32_bf16 v[120:123], v[176:179], a[52:55], v[120:123]
	v_mfma_f32_16x16x32_bf16 v[128:131], a[0:3], a[52:55], v[128:131]
	v_mfma_f32_16x16x32_bf16 v[136:139], a[4:7], a[52:55], v[136:139]
	v_mfma_f32_16x16x32_bf16 v[144:147], a[8:11], a[52:55], v[144:147]
	v_mfma_f32_16x16x32_bf16 v[152:155], a[12:15], a[52:55], v[152:155]
	s_waitcnt vmcnt(6)
	s_waitcnt lgkmcnt(0)
	s_barrier
	v_mfma_f32_16x16x32_bf16 v[36:39], a[56:59], v[180:183], v[36:39]
	ds_read_b128 v[176:179], v28 offset:37120
	v_mfma_f32_16x16x32_bf16 v[44:47], a[56:59], a[16:19], v[44:47]
	buffer_load_dwordx4 v13, s[8:11], s94 offen offset:1024 lds
	v_mfma_f32_16x16x32_bf16 v[52:55], a[56:59], a[20:23], v[52:55]
	ds_read_b64_tr_b16 a[32:33], v32 offset:0
	v_mfma_f32_16x16x32_bf16 v[60:63], a[56:59], a[24:27], v[60:63]
	ds_read_b64_tr_b16 a[34:35], v32 offset:512
	s_add_u32 m0, s46, 63872
	v_mfma_f32_16x16x32_bf16 v[68:71], a[56:59], a[28:31], v[68:71]
	ds_read_b128 a[0:3], v26 offset:37120
	s_add_u32 s47, s94, 896
	v_mfma_f32_16x16x32_bf16 v[40:43], a[60:63], v[180:183], v[40:43]
	ds_read_b128 a[4:7], v26 offset:39168
	v_mfma_f32_16x16x32_bf16 v[48:51], a[60:63], a[16:19], v[48:51]
	ds_read_b128 a[8:11], v26 offset:41216
	v_mfma_f32_16x16x32_bf16 v[56:59], a[60:63], a[20:23], v[56:59]
	buffer_load_dwordx4 v12, s[8:11], s47 offen offset:0 lds
	v_mfma_f32_16x16x32_bf16 v[64:67], a[60:63], a[24:27], v[64:67]
	ds_read_b128 a[12:15], v26 offset:43264
	v_mfma_f32_16x16x32_bf16 v[72:75], a[60:63], a[28:31], v[72:75]
	ds_read_b64_tr_b16 a[36:37], v33 offset:0
	v_mfma_f32_16x16x32_bf16 v[156:159], v[180:183], v[180:183], v[156:159]
	buffer_load_dwordx4 v13, s[8:11], s47 offen offset:1024 lds
	v_mfma_f32_16x16x32_bf16 v[160:163], a[16:19], a[16:19], v[160:163]
	v_mfma_f32_16x16x32_bf16 v[164:167], a[20:23], a[20:23], v[164:167]
	ds_read_b64_tr_b16 a[38:39], v33 offset:512
	ds_read_b64_tr_b16 a[40:41], v32 offset:8192
	v_mfma_f32_16x16x32_bf16 v[168:171], a[24:27], a[24:27], v[168:171]
	s_add_u32 m0, s46, 72064
	ds_read_b64_tr_b16 a[42:43], v32 offset:8704
	v_mfma_f32_16x16x32_bf16 v[172:175], a[28:31], a[28:31], v[172:175]
	s_add_u32 s47, s94, 1792
	ds_read_b64_tr_b16 a[44:45], v33 offset:8192
	v_mfma_f32_16x16x32_bf16 v[76:79], a[64:67], v[180:183], v[76:79]
	ds_read_b64_tr_b16 a[46:47], v33 offset:8704
	v_mfma_f32_16x16x32_bf16 v[84:87], a[64:67], a[16:19], v[84:87]
	s_mov_b64 exec, s[60:61]
	buffer_load_dwordx4 v12, s[8:11], s47 offen offset:0 lds
	s_mov_b64 exec, -1
	v_mfma_f32_16x16x32_bf16 v[92:95], a[64:67], a[20:23], v[92:95]
	v_mfma_f32_16x16x32_bf16 v[100:103], a[64:67], a[24:27], v[100:103]
	ds_read_b64_tr_b16 a[48:49], v32 offset:16384
	v_mfma_f32_16x16x32_bf16 v[108:111], a[64:67], a[28:31], v[108:111]
	ds_read_b64_tr_b16 a[50:51], v32 offset:16896
	v_mfma_f32_16x16x32_bf16 v[80:83], a[68:71], v[180:183], v[80:83]
	ds_read_b64_tr_b16 a[52:53], v33 offset:16384
	ds_read_b64_tr_b16 a[54:55], v33 offset:16896
	v_mfma_f32_16x16x32_bf16 v[88:91], a[68:71], a[16:19], v[88:91]
	s_mov_b64 exec, s[62:63]
	buffer_load_dwordx4 v13, s[8:11], s47 offen offset:1024 lds
	s_mov_b64 exec, -1
	v_mfma_f32_16x16x32_bf16 v[96:99], a[68:71], a[20:23], v[96:99]
	v_mfma_f32_16x16x32_bf16 v[104:107], a[68:71], a[24:27], v[104:107]
	v_mfma_f32_16x16x32_bf16 v[112:115], a[68:71], a[28:31], v[112:115]
	v_mfma_f32_16x16x32_bf16 v[116:119], v[180:183], a[72:75], v[116:119]
	v_mfma_f32_16x16x32_bf16 v[124:127], a[16:19], a[72:75], v[124:127]
	v_mfma_f32_16x16x32_bf16 v[132:135], a[20:23], a[72:75], v[132:135]
	v_mfma_f32_16x16x32_bf16 v[140:143], a[24:27], a[72:75], v[140:143]
	v_mfma_f32_16x16x32_bf16 v[148:151], a[28:31], a[72:75], v[148:151]
	v_mfma_f32_16x16x32_bf16 v[120:123], v[180:183], a[76:79], v[120:123]
	v_mfma_f32_16x16x32_bf16 v[128:131], a[16:19], a[76:79], v[128:131]
	v_mfma_f32_16x16x32_bf16 v[136:139], a[20:23], a[76:79], v[136:139]
	v_mfma_f32_16x16x32_bf16 v[144:147], a[24:27], a[76:79], v[144:147]
	v_mfma_f32_16x16x32_bf16 v[152:155], a[28:31], a[76:79], v[152:155]
	s_waitcnt lgkmcnt(0)
	v_mfma_f32_16x16x32_bf16 v[36:39], a[32:35], v[176:179], v[36:39]
	ds_read_b128 v[180:183], v29 offset:37120
	s_add_u32 m0, s43, 18560
	v_mfma_f32_16x16x32_bf16 v[44:47], a[32:35], a[0:3], v[44:47]
	ds_read_b64_tr_b16 a[56:57], v32 offset:4096
	s_add_u32 s47, s42, s88
	v_mfma_f32_16x16x32_bf16 v[52:55], a[32:35], a[4:7], v[52:55]
	ds_read_b64_tr_b16 a[58:59], v32 offset:4608
	v_mfma_f32_16x16x32_bf16 v[60:63], a[32:35], a[8:11], v[60:63]
	buffer_load_dwordx4 v7, s[4:7], s47 offen offset:0 lds
	v_mfma_f32_16x16x32_bf16 v[68:71], a[32:35], a[12:15], v[68:71]
	ds_read_b128 a[16:19], v27 offset:37120
	v_mfma_f32_16x16x32_bf16 v[40:43], a[36:39], v[176:179], v[40:43]
	ds_read_b128 a[20:23], v27 offset:39168
	v_mfma_f32_16x16x32_bf16 v[48:51], a[36:39], a[0:3], v[48:51]
	ds_read_b128 a[24:27], v27 offset:41216
	v_mfma_f32_16x16x32_bf16 v[56:59], a[36:39], a[4:7], v[56:59]
	buffer_load_dwordx4 v8, s[4:7], s47 offen offset:1024 lds
	v_mfma_f32_16x16x32_bf16 v[64:67], a[36:39], a[8:11], v[64:67]
	ds_read_b128 a[28:31], v27 offset:43264
	v_mfma_f32_16x16x32_bf16 v[72:75], a[36:39], a[12:15], v[72:75]
	ds_read_b64_tr_b16 a[60:61], v33 offset:4096
	v_mfma_f32_16x16x32_bf16 v[156:159], v[176:179], v[176:179], v[156:159]
	s_mov_b32 s55, 98
	v_mfma_f32_16x16x32_bf16 v[160:163], a[0:3], a[0:3], v[160:163]
	buffer_load_dwordx4 v9, s[4:7], s47 offen offset:2048 lds
	v_mfma_f32_16x16x32_bf16 v[164:167], a[4:7], a[4:7], v[164:167]
	ds_read_b64_tr_b16 a[62:63], v33 offset:4608
	v_mfma_f32_16x16x32_bf16 v[168:171], a[8:11], a[8:11], v[168:171]
	s_mul_i32 s57, s32, 33
	s_cmp_eq_u32 s32, 3
	s_cselect_b32 s56, 25, s55
	s_cselect_b32 s57, 0, s57
	s_cselect_b32 s55, 25, 33
	v_mfma_f32_16x16x32_bf16 v[172:175], a[12:15], a[12:15], v[172:175]
	ds_read_b64_tr_b16 a[64:65], v32 offset:12288
	v_mfma_f32_16x16x32_bf16 v[76:79], a[40:43], v[176:179], v[76:79]
	buffer_load_dwordx4 v10, s[4:7], s47 offen offset:3072 lds
	v_mfma_f32_16x16x32_bf16 v[84:87], a[40:43], a[0:3], v[84:87]
	ds_read_b64_tr_b16 a[66:67], v32 offset:12800
	v_mfma_f32_16x16x32_bf16 v[92:95], a[40:43], a[4:7], v[92:95]
	ds_read_b64_tr_b16 a[68:69], v33 offset:12288
	s_add_u32 m0, s44, 18560
	v_mfma_f32_16x16x32_bf16 v[100:103], a[40:43], a[8:11], v[100:103]
	s_sub_u32 s54, s2, 128
	ds_read_b64_tr_b16 a[70:71], v33 offset:12800
	v_mfma_f32_16x16x32_bf16 v[108:111], a[40:43], a[12:15], v[108:111]
	s_mul_i32 s56, s56, s54
	ds_read_b64_tr_b16 a[72:73], v32 offset:20480
	v_mfma_f32_16x16x32_bf16 v[80:83], a[44:47], v[176:179], v[80:83]
	s_add_u32 s56, s56, s57
	v_add_u32 v5, s56, v0
	v_mfma_f32_16x16x32_bf16 v[88:91], a[44:47], a[0:3], v[88:91]
	ds_read_b64_tr_b16 a[74:75], v32 offset:20992
	v_mfma_f32_16x16x32_bf16 v[96:99], a[44:47], a[4:7], v[96:99]
	s_mov_b32 exec_hi, 0
	buffer_load_dwordx4 v11, s[4:7], s88 offen lds
	s_mov_b32 exec_hi, -1
	v_mfma_f32_16x16x32_bf16 v[104:107], a[44:47], a[8:11], v[104:107]
	v_mfma_f32_16x16x32_bf16 v[112:115], a[44:47], a[12:15], v[112:115]
	v_lshlrev_b32 v5, 7, v5
	v_mfma_f32_16x16x32_bf16 v[116:119], v[176:179], a[48:51], v[116:119]
	ds_read_b64_tr_b16 a[76:77], v33 offset:20480
	v_mfma_f32_16x16x32_bf16 v[124:127], a[0:3], a[48:51], v[124:127]
	ds_read_b64_tr_b16 a[78:79], v33 offset:20992
	v_mfma_f32_16x16x32_bf16 v[132:135], a[4:7], a[48:51], v[132:135]
	v_cmp_gt_u32 vcc, s55, v0
	s_nop 1
	v_cndmask_b32 v5, 2.0, v5, vcc
	v_mfma_f32_16x16x32_bf16 v[140:143], a[8:11], a[48:51], v[140:143]
	s_add_u32 m0, s46, 80256
	v_mfma_f32_16x16x32_bf16 v[148:151], a[12:15], a[48:51], v[148:151]
	buffer_load_dword v242, v5, s[16:19], 0 offen
	v_mfma_f32_16x16x32_bf16 v[120:123], v[176:179], a[52:55], v[120:123]
	buffer_load_dwordx4 v12, s[8:11], s95 offen offset:0 lds
	v_mfma_f32_16x16x32_bf16 v[128:131], a[0:3], a[52:55], v[128:131]
	v_mfma_f32_16x16x32_bf16 v[136:139], a[4:7], a[52:55], v[136:139]
	v_mfma_f32_16x16x32_bf16 v[144:147], a[8:11], a[52:55], v[144:147]
	v_mfma_f32_16x16x32_bf16 v[152:155], a[12:15], a[52:55], v[152:155]
	s_waitcnt vmcnt(7)
	s_waitcnt lgkmcnt(0)
	s_barrier
	v_mfma_f32_16x16x32_bf16 v[36:39], a[56:59], v[180:183], v[36:39]
	ds_read_b128 v[176:179], v28 offset:0
	v_mfma_f32_16x16x32_bf16 v[44:47], a[56:59], a[16:19], v[44:47]
	buffer_load_dwordx4 v13, s[8:11], s95 offen offset:1024 lds
	v_mfma_f32_16x16x32_bf16 v[52:55], a[56:59], a[20:23], v[52:55]
	ds_read_b64_tr_b16 a[32:33], v30 offset:0
	v_mfma_f32_16x16x32_bf16 v[60:63], a[56:59], a[24:27], v[60:63]
	ds_read_b64_tr_b16 a[34:35], v30 offset:512
	s_add_u32 m0, s46, 88448
	v_mfma_f32_16x16x32_bf16 v[68:71], a[56:59], a[28:31], v[68:71]
	ds_read_b128 a[0:3], v26 offset:0
	s_add_u32 s47, s95, 896
	v_mfma_f32_16x16x32_bf16 v[40:43], a[60:63], v[180:183], v[40:43]
	ds_read_b128 a[4:7], v26 offset:2048
	v_mfma_f32_16x16x32_bf16 v[48:51], a[60:63], a[16:19], v[48:51]
	ds_read_b128 a[8:11], v26 offset:4096
	v_mfma_f32_16x16x32_bf16 v[56:59], a[60:63], a[20:23], v[56:59]
	buffer_load_dwordx4 v12, s[8:11], s47 offen offset:0 lds
	v_mfma_f32_16x16x32_bf16 v[64:67], a[60:63], a[24:27], v[64:67]
	ds_read_b128 a[12:15], v26 offset:6144
	v_mfma_f32_16x16x32_bf16 v[72:75], a[60:63], a[28:31], v[72:75]
	ds_read_b64_tr_b16 a[36:37], v31 offset:0
	v_mfma_f32_16x16x32_bf16 v[156:159], v[180:183], v[180:183], v[156:159]
	buffer_load_dwordx4 v13, s[8:11], s47 offen offset:1024 lds
	v_mfma_f32_16x16x32_bf16 v[160:163], a[16:19], a[16:19], v[160:163]
	v_mfma_f32_16x16x32_bf16 v[164:167], a[20:23], a[20:23], v[164:167]
	ds_read_b64_tr_b16 a[38:39], v31 offset:512
	ds_read_b64_tr_b16 a[40:41], v30 offset:8192
	v_mfma_f32_16x16x32_bf16 v[168:171], a[24:27], a[24:27], v[168:171]
	s_add_u32 m0, s46, 96640
	ds_read_b64_tr_b16 a[42:43], v30 offset:8704
	v_mfma_f32_16x16x32_bf16 v[172:175], a[28:31], a[28:31], v[172:175]
	s_add_u32 s47, s95, 1792
	ds_read_b64_tr_b16 a[44:45], v31 offset:8192
	v_mfma_f32_16x16x32_bf16 v[76:79], a[64:67], v[180:183], v[76:79]
	ds_read_b64_tr_b16 a[46:47], v31 offset:8704
	v_mfma_f32_16x16x32_bf16 v[84:87], a[64:67], a[16:19], v[84:87]
	s_mov_b64 exec, s[60:61]
	buffer_load_dwordx4 v12, s[8:11], s47 offen offset:0 lds
	s_mov_b64 exec, -1
	v_mfma_f32_16x16x32_bf16 v[92:95], a[64:67], a[20:23], v[92:95]
	v_mfma_f32_16x16x32_bf16 v[100:103], a[64:67], a[24:27], v[100:103]
	ds_read_b64_tr_b16 a[48:49], v30 offset:16384
	v_mfma_f32_16x16x32_bf16 v[108:111], a[64:67], a[28:31], v[108:111]
	ds_read_b64_tr_b16 a[50:51], v30 offset:16896
	v_mfma_f32_16x16x32_bf16 v[80:83], a[68:71], v[180:183], v[80:83]
	ds_read_b64_tr_b16 a[52:53], v31 offset:16384
	ds_read_b64_tr_b16 a[54:55], v31 offset:16896
	v_mfma_f32_16x16x32_bf16 v[88:91], a[68:71], a[16:19], v[88:91]
	s_mov_b64 exec, s[62:63]
	buffer_load_dwordx4 v13, s[8:11], s47 offen offset:1024 lds
	s_mov_b64 exec, -1
	v_mfma_f32_16x16x32_bf16 v[96:99], a[68:71], a[20:23], v[96:99]
	v_mfma_f32_16x16x32_bf16 v[104:107], a[68:71], a[24:27], v[104:107]
	v_mfma_f32_16x16x32_bf16 v[112:115], a[68:71], a[28:31], v[112:115]
	v_mfma_f32_16x16x32_bf16 v[116:119], v[180:183], a[72:75], v[116:119]
	v_mfma_f32_16x16x32_bf16 v[124:127], a[16:19], a[72:75], v[124:127]
	v_mfma_f32_16x16x32_bf16 v[132:135], a[20:23], a[72:75], v[132:135]
	v_mfma_f32_16x16x32_bf16 v[140:143], a[24:27], a[72:75], v[140:143]
	v_mfma_f32_16x16x32_bf16 v[148:151], a[28:31], a[72:75], v[148:151]
	v_mfma_f32_16x16x32_bf16 v[120:123], v[180:183], a[76:79], v[120:123]
	v_mfma_f32_16x16x32_bf16 v[128:131], a[16:19], a[76:79], v[128:131]
	v_mfma_f32_16x16x32_bf16 v[136:139], a[20:23], a[76:79], v[136:139]
	v_mfma_f32_16x16x32_bf16 v[144:147], a[24:27], a[76:79], v[144:147]
	v_mfma_f32_16x16x32_bf16 v[152:155], a[28:31], a[76:79], v[152:155]
	s_waitcnt lgkmcnt(0)
	v_mfma_f32_16x16x32_bf16 v[36:39], a[32:35], v[176:179], v[36:39]
	ds_read_b128 v[180:183], v29 offset:0
	s_add_u32 m0, s43, 37120
	v_mfma_f32_16x16x32_bf16 v[44:47], a[32:35], a[0:3], v[44:47]
	ds_read_b64_tr_b16 a[56:57], v30 offset:4096
	s_add_u32 s47, s42, s89
	v_mfma_f32_16x16x32_bf16 v[52:55], a[32:35], a[4:7], v[52:55]
	ds_read_b64_tr_b16 a[58:59], v30 offset:4608
	v_mfma_f32_16x16x32_bf16 v[60:63], a[32:35], a[8:11], v[60:63]
	buffer_load_dwordx4 v7, s[4:7], s47 offen offset:0 lds
	v_mfma_f32_16x16x32_bf16 v[68:71], a[32:35], a[12:15], v[68:71]
	ds_read_b128 a[16:19], v27 offset:0
	v_mfma_f32_16x16x32_bf16 v[40:43], a[36:39], v[176:179], v[40:43]
	ds_read_b128 a[20:23], v27 offset:2048
	v_mfma_f32_16x16x32_bf16 v[48:51], a[36:39], a[0:3], v[48:51]
	ds_read_b128 a[24:27], v27 offset:4096
	v_mfma_f32_16x16x32_bf16 v[56:59], a[36:39], a[4:7], v[56:59]
	buffer_load_dwordx4 v8, s[4:7], s47 offen offset:1024 lds
	v_mfma_f32_16x16x32_bf16 v[64:67], a[36:39], a[8:11], v[64:67]
	ds_read_b128 a[28:31], v27 offset:6144
	v_mfma_f32_16x16x32_bf16 v[72:75], a[36:39], a[12:15], v[72:75]
	ds_read_b64_tr_b16 a[60:61], v31 offset:4096
	v_mfma_f32_16x16x32_bf16 v[156:159], v[176:179], v[176:179], v[156:159]
	buffer_load_dwordx4 v9, s[4:7], s47 offen offset:2048 lds
	v_mfma_f32_16x16x32_bf16 v[160:163], a[0:3], a[0:3], v[160:163]
	v_mfma_f32_16x16x32_bf16 v[164:167], a[4:7], a[4:7], v[164:167]
	ds_read_b64_tr_b16 a[62:63], v31 offset:4608
	ds_read_b64_tr_b16 a[64:65], v30 offset:12288
	v_mfma_f32_16x16x32_bf16 v[168:171], a[8:11], a[8:11], v[168:171]
	buffer_load_dwordx4 v10, s[4:7], s47 offen offset:3072 lds
	v_mfma_f32_16x16x32_bf16 v[172:175], a[12:15], a[12:15], v[172:175]
	v_mfma_f32_16x16x32_bf16 v[76:79], a[40:43], v[176:179], v[76:79]
	ds_read_b64_tr_b16 a[66:67], v30 offset:12800
	v_mfma_f32_16x16x32_bf16 v[84:87], a[40:43], a[0:3], v[84:87]
	ds_read_b64_tr_b16 a[68:69], v31 offset:12288
	s_add_u32 m0, s44, 37120
	v_mfma_f32_16x16x32_bf16 v[92:95], a[40:43], a[4:7], v[92:95]
	ds_read_b64_tr_b16 a[70:71], v31 offset:12800
	v_mfma_f32_16x16x32_bf16 v[100:103], a[40:43], a[8:11], v[100:103]
	buffer_load_dword v243, off, s[20:23], 0
	v_mfma_f32_16x16x32_bf16 v[108:111], a[40:43], a[12:15], v[108:111]
	ds_read_b64_tr_b16 a[72:73], v30 offset:20480
	v_mfma_f32_16x16x32_bf16 v[80:83], a[44:47], v[176:179], v[80:83]
	ds_read_b64_tr_b16 a[74:75], v30 offset:20992
	v_mfma_f32_16x16x32_bf16 v[88:91], a[44:47], a[0:3], v[88:91]
	s_mov_b32 exec_hi, 0
	buffer_load_dwordx4 v11, s[4:7], s89 offen lds
	s_mov_b32 exec_hi, -1
	v_mfma_f32_16x16x32_bf16 v[96:99], a[44:47], a[4:7], v[96:99]
	v_mfma_f32_16x16x32_bf16 v[104:107], a[44:47], a[8:11], v[104:107]
	ds_read_b64_tr_b16 a[76:77], v31 offset:20480
	v_mfma_f32_16x16x32_bf16 v[112:115], a[44:47], a[12:15], v[112:115]
	ds_read_b64_tr_b16 a[78:79], v31 offset:20992
	s_add_u32 m0, s46, 104832
	v_mfma_f32_16x16x32_bf16 v[116:119], v[176:179], a[48:51], v[116:119]
	buffer_load_dwordx4 v12, s[8:11], s96 offen offset:0 lds
	v_mfma_f32_16x16x32_bf16 v[124:127], a[0:3], a[48:51], v[124:127]
	v_mfma_f32_16x16x32_bf16 v[132:135], a[4:7], a[48:51], v[132:135]
	v_mfma_f32_16x16x32_bf16 v[140:143], a[8:11], a[48:51], v[140:143]
	v_mfma_f32_16x16x32_bf16 v[148:151], a[12:15], a[48:51], v[148:151]
	v_mfma_f32_16x16x32_bf16 v[120:123], v[176:179], a[52:55], v[120:123]
	v_mfma_f32_16x16x32_bf16 v[128:131], a[0:3], a[52:55], v[128:131]
	v_mfma_f32_16x16x32_bf16 v[136:139], a[4:7], a[52:55], v[136:139]
	v_mfma_f32_16x16x32_bf16 v[144:147], a[8:11], a[52:55], v[144:147]
	v_mfma_f32_16x16x32_bf16 v[152:155], a[12:15], a[52:55], v[152:155]
	s_waitcnt vmcnt(7)
	s_waitcnt lgkmcnt(0)
	s_barrier
	v_mfma_f32_16x16x32_bf16 v[36:39], a[56:59], v[180:183], v[36:39]
	ds_read_b128 v[176:179], v28 offset:18560
	v_mfma_f32_16x16x32_bf16 v[44:47], a[56:59], a[16:19], v[44:47]
	buffer_load_dwordx4 v13, s[8:11], s96 offen offset:1024 lds
	v_mfma_f32_16x16x32_bf16 v[52:55], a[56:59], a[20:23], v[52:55]
	ds_read_b64_tr_b16 a[32:33], v30 offset:24576
	v_mfma_f32_16x16x32_bf16 v[60:63], a[56:59], a[24:27], v[60:63]
	ds_read_b64_tr_b16 a[34:35], v30 offset:25088
	s_add_u32 m0, s46, 113024
	v_mfma_f32_16x16x32_bf16 v[68:71], a[56:59], a[28:31], v[68:71]
	ds_read_b128 a[0:3], v26 offset:18560
	s_add_u32 s47, s96, 896
	v_mfma_f32_16x16x32_bf16 v[40:43], a[60:63], v[180:183], v[40:43]
	ds_read_b128 a[4:7], v26 offset:20608
	v_mfma_f32_16x16x32_bf16 v[48:51], a[60:63], a[16:19], v[48:51]
	ds_read_b128 a[8:11], v26 offset:22656
	v_mfma_f32_16x16x32_bf16 v[56:59], a[60:63], a[20:23], v[56:59]
	buffer_load_dwordx4 v12, s[8:11], s47 offen offset:0 lds
	v_mfma_f32_16x16x32_bf16 v[64:67], a[60:63], a[24:27], v[64:67]
	ds_read_b128 a[12:15], v26 offset:24704
	v_mfma_f32_16x16x32_bf16 v[72:75], a[60:63], a[28:31], v[72:75]
	ds_read_b64_tr_b16 a[36:37], v31 offset:24576
	v_mfma_f32_16x16x32_bf16 v[156:159], v[180:183], v[180:183], v[156:159]
	buffer_load_dwordx4 v13, s[8:11], s47 offen offset:1024 lds
	v_mfma_f32_16x16x32_bf16 v[160:163], a[16:19], a[16:19], v[160:163]
	v_mfma_f32_16x16x32_bf16 v[164:167], a[20:23], a[20:23], v[164:167]
	ds_read_b64_tr_b16 a[38:39], v31 offset:25088
	ds_read_b64_tr_b16 a[40:41], v30 offset:32768
	v_mfma_f32_16x16x32_bf16 v[168:171], a[24:27], a[24:27], v[168:171]
	s_add_u32 m0, s46, 121216
	ds_read_b64_tr_b16 a[42:43], v30 offset:33280
	v_mfma_f32_16x16x32_bf16 v[172:175], a[28:31], a[28:31], v[172:175]
	s_add_u32 s47, s96, 1792
	ds_read_b64_tr_b16 a[44:45], v31 offset:32768
	v_mfma_f32_16x16x32_bf16 v[76:79], a[64:67], v[180:183], v[76:79]
	ds_read_b64_tr_b16 a[46:47], v31 offset:33280
	v_mfma_f32_16x16x32_bf16 v[84:87], a[64:67], a[16:19], v[84:87]
	s_mov_b64 exec, s[60:61]
	buffer_load_dwordx4 v12, s[8:11], s47 offen offset:0 lds
	s_mov_b64 exec, -1
	v_mfma_f32_16x16x32_bf16 v[92:95], a[64:67], a[20:23], v[92:95]
	v_mfma_f32_16x16x32_bf16 v[100:103], a[64:67], a[24:27], v[100:103]
	ds_read_b64_tr_b16 a[48:49], v30 offset:40960
	v_mfma_f32_16x16x32_bf16 v[108:111], a[64:67], a[28:31], v[108:111]
	ds_read_b64_tr_b16 a[50:51], v30 offset:41472
	v_mfma_f32_16x16x32_bf16 v[80:83], a[68:71], v[180:183], v[80:83]
	ds_read_b64_tr_b16 a[52:53], v31 offset:40960
	ds_read_b64_tr_b16 a[54:55], v31 offset:41472
	v_mfma_f32_16x16x32_bf16 v[88:91], a[68:71], a[16:19], v[88:91]
	s_mov_b64 exec, s[62:63]
	buffer_load_dwordx4 v13, s[8:11], s47 offen offset:1024 lds
	s_mov_b64 exec, -1
	v_mfma_f32_16x16x32_bf16 v[96:99], a[68:71], a[20:23], v[96:99]
	v_mfma_f32_16x16x32_bf16 v[104:107], a[68:71], a[24:27], v[104:107]
	v_mfma_f32_16x16x32_bf16 v[112:115], a[68:71], a[28:31], v[112:115]
	v_mfma_f32_16x16x32_bf16 v[116:119], v[180:183], a[72:75], v[116:119]
	v_mfma_f32_16x16x32_bf16 v[124:127], a[16:19], a[72:75], v[124:127]
	v_mfma_f32_16x16x32_bf16 v[132:135], a[20:23], a[72:75], v[132:135]
	v_mfma_f32_16x16x32_bf16 v[140:143], a[24:27], a[72:75], v[140:143]
	v_mfma_f32_16x16x32_bf16 v[148:151], a[28:31], a[72:75], v[148:151]
	v_mfma_f32_16x16x32_bf16 v[120:123], v[180:183], a[76:79], v[120:123]
	v_mfma_f32_16x16x32_bf16 v[128:131], a[16:19], a[76:79], v[128:131]
	v_mfma_f32_16x16x32_bf16 v[136:139], a[20:23], a[76:79], v[136:139]
	v_mfma_f32_16x16x32_bf16 v[144:147], a[24:27], a[76:79], v[144:147]
	v_mfma_f32_16x16x32_bf16 v[152:155], a[28:31], a[76:79], v[152:155]
	s_waitcnt lgkmcnt(0)
	v_mfma_f32_16x16x32_bf16 v[36:39], a[32:35], v[176:179], v[36:39]
	ds_read_b128 v[180:183], v29 offset:18560
	s_add_u32 m0, s43, 0
	v_mfma_f32_16x16x32_bf16 v[44:47], a[32:35], a[0:3], v[44:47]
	ds_read_b64_tr_b16 a[56:57], v30 offset:28672
	s_add_u32 s47, s42, s90
	v_mfma_f32_16x16x32_bf16 v[52:55], a[32:35], a[4:7], v[52:55]
	ds_read_b64_tr_b16 a[58:59], v30 offset:29184
	v_mfma_f32_16x16x32_bf16 v[60:63], a[32:35], a[8:11], v[60:63]
	buffer_load_dwordx4 v7, s[4:7], s47 offen offset:0 lds
	v_mfma_f32_16x16x32_bf16 v[68:71], a[32:35], a[12:15], v[68:71]
	ds_read_b128 a[16:19], v27 offset:18560
	v_mfma_f32_16x16x32_bf16 v[40:43], a[36:39], v[176:179], v[40:43]
	ds_read_b128 a[20:23], v27 offset:20608
	v_mfma_f32_16x16x32_bf16 v[48:51], a[36:39], a[0:3], v[48:51]
	ds_read_b128 a[24:27], v27 offset:22656
	v_mfma_f32_16x16x32_bf16 v[56:59], a[36:39], a[4:7], v[56:59]
	buffer_load_dwordx4 v8, s[4:7], s47 offen offset:1024 lds
	v_mfma_f32_16x16x32_bf16 v[64:67], a[36:39], a[8:11], v[64:67]
	ds_read_b128 a[28:31], v27 offset:24704
	v_mfma_f32_16x16x32_bf16 v[72:75], a[36:39], a[12:15], v[72:75]
	ds_read_b64_tr_b16 a[60:61], v31 offset:28672
	v_mfma_f32_16x16x32_bf16 v[156:159], v[176:179], v[176:179], v[156:159]
	buffer_load_dwordx4 v9, s[4:7], s47 offen offset:2048 lds
	v_mfma_f32_16x16x32_bf16 v[160:163], a[0:3], a[0:3], v[160:163]
	v_mfma_f32_16x16x32_bf16 v[164:167], a[4:7], a[4:7], v[164:167]
	ds_read_b64_tr_b16 a[62:63], v31 offset:29184
	ds_read_b64_tr_b16 a[64:65], v30 offset:36864
	v_mfma_f32_16x16x32_bf16 v[168:171], a[8:11], a[8:11], v[168:171]
	buffer_load_dwordx4 v10, s[4:7], s47 offen offset:3072 lds
	v_mfma_f32_16x16x32_bf16 v[172:175], a[12:15], a[12:15], v[172:175]
	v_mfma_f32_16x16x32_bf16 v[76:79], a[40:43], v[176:179], v[76:79]
	ds_read_b64_tr_b16 a[66:67], v30 offset:37376
	v_mfma_f32_16x16x32_bf16 v[84:87], a[40:43], a[0:3], v[84:87]
	ds_read_b64_tr_b16 a[68:69], v31 offset:36864
	s_add_u32 m0, s44, 0
	v_mfma_f32_16x16x32_bf16 v[92:95], a[40:43], a[4:7], v[92:95]
	ds_read_b64_tr_b16 a[70:71], v31 offset:37376
	ds_read_b64_tr_b16 a[72:73], v30 offset:45056
	v_mfma_f32_16x16x32_bf16 v[100:103], a[40:43], a[8:11], v[100:103]
	ds_read_b64_tr_b16 a[74:75], v30 offset:45568
	v_mfma_f32_16x16x32_bf16 v[108:111], a[40:43], a[12:15], v[108:111]
	s_mov_b32 exec_hi, 0
	buffer_load_dwordx4 v11, s[4:7], s90 offen lds
	s_mov_b32 exec_hi, -1
	v_mfma_f32_16x16x32_bf16 v[80:83], a[44:47], v[176:179], v[80:83]
	v_mfma_f32_16x16x32_bf16 v[88:91], a[44:47], a[0:3], v[88:91]
	ds_read_b64_tr_b16 a[76:77], v31 offset:45056
	v_mfma_f32_16x16x32_bf16 v[96:99], a[44:47], a[4:7], v[96:99]
	ds_read_b64_tr_b16 a[78:79], v31 offset:45568
	s_add_u32 m0, s46, 55680
	v_mfma_f32_16x16x32_bf16 v[104:107], a[44:47], a[8:11], v[104:107]
	buffer_load_dwordx4 v12, s[8:11], s97 offen offset:0 lds
	v_mfma_f32_16x16x32_bf16 v[112:115], a[44:47], a[12:15], v[112:115]
	v_mfma_f32_16x16x32_bf16 v[116:119], v[176:179], a[48:51], v[116:119]
	v_mfma_f32_16x16x32_bf16 v[124:127], a[0:3], a[48:51], v[124:127]
	v_mfma_f32_16x16x32_bf16 v[132:135], a[4:7], a[48:51], v[132:135]
	v_mfma_f32_16x16x32_bf16 v[140:143], a[8:11], a[48:51], v[140:143]
	v_mfma_f32_16x16x32_bf16 v[148:151], a[12:15], a[48:51], v[148:151]
	v_mfma_f32_16x16x32_bf16 v[120:123], v[176:179], a[52:55], v[120:123]
	v_mfma_f32_16x16x32_bf16 v[128:131], a[0:3], a[52:55], v[128:131]
	v_mfma_f32_16x16x32_bf16 v[136:139], a[4:7], a[52:55], v[136:139]
	v_mfma_f32_16x16x32_bf16 v[144:147], a[8:11], a[52:55], v[144:147]
	v_mfma_f32_16x16x32_bf16 v[152:155], a[12:15], a[52:55], v[152:155]
	s_waitcnt vmcnt(6)
	s_waitcnt lgkmcnt(0)
	s_barrier
	v_mfma_f32_16x16x32_bf16 v[36:39], a[56:59], v[180:183], v[36:39]
	ds_read_b128 v[176:179], v28 offset:37120
	v_mfma_f32_16x16x32_bf16 v[44:47], a[56:59], a[16:19], v[44:47]
	buffer_load_dwordx4 v13, s[8:11], s97 offen offset:1024 lds
	v_mfma_f32_16x16x32_bf16 v[52:55], a[56:59], a[20:23], v[52:55]
	ds_read_b64_tr_b16 a[32:33], v32 offset:0
	v_mfma_f32_16x16x32_bf16 v[60:63], a[56:59], a[24:27], v[60:63]
	ds_read_b64_tr_b16 a[34:35], v32 offset:512
	s_add_u32 m0, s46, 63872
	v_mfma_f32_16x16x32_bf16 v[68:71], a[56:59], a[28:31], v[68:71]
	ds_read_b128 a[0:3], v26 offset:37120
	s_add_u32 s47, s97, 896
	v_mfma_f32_16x16x32_bf16 v[40:43], a[60:63], v[180:183], v[40:43]
	ds_read_b128 a[4:7], v26 offset:39168
	v_mfma_f32_16x16x32_bf16 v[48:51], a[60:63], a[16:19], v[48:51]
	ds_read_b128 a[8:11], v26 offset:41216
	v_mfma_f32_16x16x32_bf16 v[56:59], a[60:63], a[20:23], v[56:59]
	buffer_load_dwordx4 v12, s[8:11], s47 offen offset:0 lds
	v_mfma_f32_16x16x32_bf16 v[64:67], a[60:63], a[24:27], v[64:67]
	ds_read_b128 a[12:15], v26 offset:43264
	v_mfma_f32_16x16x32_bf16 v[72:75], a[60:63], a[28:31], v[72:75]
	ds_read_b64_tr_b16 a[36:37], v33 offset:0
	v_mfma_f32_16x16x32_bf16 v[156:159], v[180:183], v[180:183], v[156:159]
	buffer_load_dwordx4 v13, s[8:11], s47 offen offset:1024 lds
	v_mfma_f32_16x16x32_bf16 v[160:163], a[16:19], a[16:19], v[160:163]
	v_mfma_f32_16x16x32_bf16 v[164:167], a[20:23], a[20:23], v[164:167]
	ds_read_b64_tr_b16 a[38:39], v33 offset:512
	ds_read_b64_tr_b16 a[40:41], v32 offset:8192
	v_mfma_f32_16x16x32_bf16 v[168:171], a[24:27], a[24:27], v[168:171]
	s_add_u32 m0, s46, 72064
	ds_read_b64_tr_b16 a[42:43], v32 offset:8704
	v_mfma_f32_16x16x32_bf16 v[172:175], a[28:31], a[28:31], v[172:175]
	s_add_u32 s47, s97, 1792
	ds_read_b64_tr_b16 a[44:45], v33 offset:8192
	v_mfma_f32_16x16x32_bf16 v[76:79], a[64:67], v[180:183], v[76:79]
	ds_read_b64_tr_b16 a[46:47], v33 offset:8704
	v_mfma_f32_16x16x32_bf16 v[84:87], a[64:67], a[16:19], v[84:87]
	s_mov_b64 exec, s[60:61]
	buffer_load_dwordx4 v12, s[8:11], s47 offen offset:0 lds
	s_mov_b64 exec, -1
	v_mfma_f32_16x16x32_bf16 v[92:95], a[64:67], a[20:23], v[92:95]
	v_mfma_f32_16x16x32_bf16 v[100:103], a[64:67], a[24:27], v[100:103]
	ds_read_b64_tr_b16 a[48:49], v32 offset:16384
	v_mfma_f32_16x16x32_bf16 v[108:111], a[64:67], a[28:31], v[108:111]
	ds_read_b64_tr_b16 a[50:51], v32 offset:16896
	v_mfma_f32_16x16x32_bf16 v[80:83], a[68:71], v[180:183], v[80:83]
	ds_read_b64_tr_b16 a[52:53], v33 offset:16384
	ds_read_b64_tr_b16 a[54:55], v33 offset:16896
	v_mfma_f32_16x16x32_bf16 v[88:91], a[68:71], a[16:19], v[88:91]
	s_mov_b64 exec, s[62:63]
	buffer_load_dwordx4 v13, s[8:11], s47 offen offset:1024 lds
	s_mov_b64 exec, -1
	v_mfma_f32_16x16x32_bf16 v[96:99], a[68:71], a[20:23], v[96:99]
	v_mfma_f32_16x16x32_bf16 v[104:107], a[68:71], a[24:27], v[104:107]
	v_mfma_f32_16x16x32_bf16 v[112:115], a[68:71], a[28:31], v[112:115]
	v_mfma_f32_16x16x32_bf16 v[116:119], v[180:183], a[72:75], v[116:119]
	v_mfma_f32_16x16x32_bf16 v[124:127], a[16:19], a[72:75], v[124:127]
	v_mfma_f32_16x16x32_bf16 v[132:135], a[20:23], a[72:75], v[132:135]
	v_mfma_f32_16x16x32_bf16 v[140:143], a[24:27], a[72:75], v[140:143]
	v_mfma_f32_16x16x32_bf16 v[148:151], a[28:31], a[72:75], v[148:151]
	v_mfma_f32_16x16x32_bf16 v[120:123], v[180:183], a[76:79], v[120:123]
	v_mfma_f32_16x16x32_bf16 v[128:131], a[16:19], a[76:79], v[128:131]
	v_mfma_f32_16x16x32_bf16 v[136:139], a[20:23], a[76:79], v[136:139]
	v_mfma_f32_16x16x32_bf16 v[144:147], a[24:27], a[76:79], v[144:147]
	v_mfma_f32_16x16x32_bf16 v[152:155], a[28:31], a[76:79], v[152:155]
	s_waitcnt lgkmcnt(0)
	v_mfma_f32_16x16x32_bf16 v[36:39], a[32:35], v[176:179], v[36:39]
	s_mul_i32 s82, s72, 0
	ds_read_b128 v[180:183], v29 offset:37120
	s_add_u32 m0, s80, 16384
	v_mfma_f32_16x16x32_bf16 v[44:47], a[32:35], a[0:3], v[44:47]
	ds_read_b64_tr_b16 a[56:57], v32 offset:4096
	s_add_u32 s82, s82, s73
	v_mfma_f32_16x16x32_bf16 v[52:55], a[32:35], a[4:7], v[52:55]
	ds_read_b64_tr_b16 a[58:59], v32 offset:4608
	v_mfma_f32_16x16x32_bf16 v[60:63], a[32:35], a[8:11], v[60:63]
	ds_read_b128 a[16:19], v27 offset:37120
	v_mfma_f32_16x16x32_bf16 v[68:71], a[32:35], a[12:15], v[68:71]
	buffer_load_dwordx4 v244, s[16:19], s82 offen offset:0 lds
	v_mfma_f32_16x16x32_bf16 v[40:43], a[36:39], v[176:179], v[40:43]
	ds_read_b128 a[20:23], v27 offset:39168
	v_mfma_f32_16x16x32_bf16 v[48:51], a[36:39], a[0:3], v[48:51]
	ds_read_b128 a[24:27], v27 offset:41216
	v_mfma_f32_16x16x32_bf16 v[56:59], a[36:39], a[4:7], v[56:59]
	buffer_load_dwordx4 v245, s[16:19], s82 offen offset:1024 lds
	v_mfma_f32_16x16x32_bf16 v[64:67], a[36:39], a[8:11], v[64:67]
	v_mfma_f32_16x16x32_bf16 v[72:75], a[36:39], a[12:15], v[72:75]
	ds_read_b128 a[28:31], v27 offset:43264
	v_mfma_f32_16x16x32_bf16 v[156:159], v[176:179], v[176:179], v[156:159]
	buffer_load_dwordx4 v246, s[16:19], s82 offen offset:2048 lds
	v_mfma_f32_16x16x32_bf16 v[160:163], a[0:3], a[0:3], v[160:163]
	ds_read_b64_tr_b16 a[60:61], v33 offset:4096
	v_mfma_f32_16x16x32_bf16 v[164:167], a[4:7], a[4:7], v[164:167]
	ds_read_b64_tr_b16 a[62:63], v33 offset:4608
	v_mfma_f32_16x16x32_bf16 v[168:171], a[8:11], a[8:11], v[168:171]
	buffer_load_dwordx4 v247, s[16:19], s82 offen offset:3072 lds
	v_mfma_f32_16x16x32_bf16 v[172:175], a[12:15], a[12:15], v[172:175]
	ds_read_b64_tr_b16 a[64:65], v32 offset:12288
	v_mfma_f32_16x16x32_bf16 v[76:79], a[40:43], v[176:179], v[76:79]
	ds_read_b64_tr_b16 a[66:67], v32 offset:12800
	s_mul_i32 s82, s72, 0
	v_mfma_f32_16x16x32_bf16 v[84:87], a[40:43], a[0:3], v[84:87]
	s_add_u32 m0, s80, 70656
	ds_read_b64_tr_b16 a[68:69], v33 offset:12288
	v_mfma_f32_16x16x32_bf16 v[92:95], a[40:43], a[4:7], v[92:95]
	s_add_u32 s82, s82, s74
	ds_read_b64_tr_b16 a[70:71], v33 offset:12800
	v_mfma_f32_16x16x32_bf16 v[100:103], a[40:43], a[8:11], v[100:103]
	ds_read_b64_tr_b16 a[72:73], v32 offset:20480
	v_mfma_f32_16x16x32_bf16 v[108:111], a[40:43], a[12:15], v[108:111]
	buffer_load_dwordx4 v244, s[16:19], s82 offen offset:0 lds
	v_mfma_f32_16x16x32_bf16 v[80:83], a[44:47], v[176:179], v[80:83]
	v_mfma_f32_16x16x32_bf16 v[88:91], a[44:47], a[0:3], v[88:91]
	ds_read_b64_tr_b16 a[74:75], v32 offset:20992
	ds_read_b64_tr_b16 a[76:77], v33 offset:20480
	v_mfma_f32_16x16x32_bf16 v[96:99], a[44:47], a[4:7], v[96:99]
	buffer_load_dwordx4 v245, s[16:19], s82 offen offset:1024 lds
	v_mfma_f32_16x16x32_bf16 v[104:107], a[44:47], a[8:11], v[104:107]
	v_mfma_f32_16x16x32_bf16 v[112:115], a[44:47], a[12:15], v[112:115]
	ds_read_b64_tr_b16 a[78:79], v33 offset:20992
	v_mfma_f32_16x16x32_bf16 v[116:119], v[176:179], a[48:51], v[116:119]
	buffer_load_dwordx4 v246, s[16:19], s82 offen offset:2048 lds
	v_mfma_f32_16x16x32_bf16 v[124:127], a[0:3], a[48:51], v[124:127]
	buffer_load_dwordx4 v247, s[16:19], s82 offen offset:3072 lds
	v_mfma_f32_16x16x32_bf16 v[132:135], a[4:7], a[48:51], v[132:135]
	v_mfma_f32_16x16x32_bf16 v[140:143], a[8:11], a[48:51], v[140:143]
	v_mfma_f32_16x16x32_bf16 v[148:151], a[12:15], a[48:51], v[148:151]
	v_mfma_f32_16x16x32_bf16 v[120:123], v[176:179], a[52:55], v[120:123]
	v_mfma_f32_16x16x32_bf16 v[128:131], a[0:3], a[52:55], v[128:131]
	v_mfma_f32_16x16x32_bf16 v[136:139], a[4:7], a[52:55], v[136:139]
	v_mfma_f32_16x16x32_bf16 v[144:147], a[8:11], a[52:55], v[144:147]
	v_mfma_f32_16x16x32_bf16 v[152:155], a[12:15], a[52:55], v[152:155]
	s_waitcnt vmcnt(8)
	s_waitcnt lgkmcnt(0)
	s_barrier
	v_mfma_f32_16x16x32_bf16 v[36:39], a[56:59], v[180:183], v[36:39]
	s_mul_i32 s82, s72, 1
	ds_read_b128 v[176:179], v28 offset:0
	s_add_u32 m0, s80, 32768
	v_mfma_f32_16x16x32_bf16 v[44:47], a[56:59], a[16:19], v[44:47]
	ds_read_b64_tr_b16 a[32:33], v30 offset:0
	s_add_u32 s82, s82, s75
	v_mfma_f32_16x16x32_bf16 v[52:55], a[56:59], a[20:23], v[52:55]
	ds_read_b64_tr_b16 a[34:35], v30 offset:512
	v_mfma_f32_16x16x32_bf16 v[60:63], a[56:59], a[24:27], v[60:63]
	ds_read_b128 a[0:3], v26 offset:0
	v_mfma_f32_16x16x32_bf16 v[68:71], a[56:59], a[28:31], v[68:71]
	buffer_load_dwordx4 v244, s[16:19], s82 offen offset:0 lds
	v_mfma_f32_16x16x32_bf16 v[40:43], a[60:63], v[180:183], v[40:43]
	ds_read_b128 a[4:7], v26 offset:2048
	v_mfma_f32_16x16x32_bf16 v[48:51], a[60:63], a[16:19], v[48:51]
	ds_read_b128 a[8:11], v26 offset:4096
	v_mfma_f32_16x16x32_bf16 v[56:59], a[60:63], a[20:23], v[56:59]
	buffer_load_dwordx4 v245, s[16:19], s82 offen offset:1024 lds
	v_mfma_f32_16x16x32_bf16 v[64:67], a[60:63], a[24:27], v[64:67]
	v_mfma_f32_16x16x32_bf16 v[72:75], a[60:63], a[28:31], v[72:75]
	ds_read_b128 a[12:15], v26 offset:6144
	v_mfma_f32_16x16x32_bf16 v[156:159], v[180:183], v[180:183], v[156:159]
	buffer_load_dwordx4 v246, s[16:19], s82 offen offset:2048 lds
	v_mfma_f32_16x16x32_bf16 v[160:163], a[16:19], a[16:19], v[160:163]
	ds_read_b64_tr_b16 a[36:37], v31 offset:0
	v_mfma_f32_16x16x32_bf16 v[164:167], a[20:23], a[20:23], v[164:167]
	ds_read_b64_tr_b16 a[38:39], v31 offset:512
	v_mfma_f32_16x16x32_bf16 v[168:171], a[24:27], a[24:27], v[168:171]
	buffer_load_dwordx4 v247, s[16:19], s82 offen offset:3072 lds
	v_mfma_f32_16x16x32_bf16 v[172:175], a[28:31], a[28:31], v[172:175]
	ds_read_b64_tr_b16 a[40:41], v30 offset:8192
	v_mfma_f32_16x16x32_bf16 v[76:79], a[64:67], v[180:183], v[76:79]
	ds_read_b64_tr_b16 a[42:43], v30 offset:8704
	s_mul_i32 s82, s72, 1
	v_mfma_f32_16x16x32_bf16 v[84:87], a[64:67], a[16:19], v[84:87]
	s_add_u32 m0, s80, 49152
	ds_read_b64_tr_b16 a[44:45], v31 offset:8192
	v_mfma_f32_16x16x32_bf16 v[92:95], a[64:67], a[20:23], v[92:95]
	s_add_u32 s82, s82, s76
	ds_read_b64_tr_b16 a[46:47], v31 offset:8704
	v_mfma_f32_16x16x32_bf16 v[100:103], a[64:67], a[24:27], v[100:103]
	ds_read_b64_tr_b16 a[48:49], v30 offset:16384
	v_mfma_f32_16x16x32_bf16 v[108:111], a[64:67], a[28:31], v[108:111]
	buffer_load_dwordx4 v244, s[16:19], s82 offen offset:0 lds
	v_mfma_f32_16x16x32_bf16 v[80:83], a[68:71], v[180:183], v[80:83]
	v_mfma_f32_16x16x32_bf16 v[88:91], a[68:71], a[16:19], v[88:91]
	ds_read_b64_tr_b16 a[50:51], v30 offset:16896
	ds_read_b64_tr_b16 a[52:53], v31 offset:16384
	v_mfma_f32_16x16x32_bf16 v[96:99], a[68:71], a[20:23], v[96:99]
	buffer_load_dwordx4 v245, s[16:19], s82 offen offset:1024 lds
	v_mfma_f32_16x16x32_bf16 v[104:107], a[68:71], a[24:27], v[104:107]
	v_mfma_f32_16x16x32_bf16 v[112:115], a[68:71], a[28:31], v[112:115]
	ds_read_b64_tr_b16 a[54:55], v31 offset:16896
	v_mfma_f32_16x16x32_bf16 v[116:119], v[180:183], a[72:75], v[116:119]
	buffer_load_dwordx4 v246, s[16:19], s82 offen offset:2048 lds
	v_mfma_f32_16x16x32_bf16 v[124:127], a[16:19], a[72:75], v[124:127]
	buffer_load_dwordx4 v247, s[16:19], s82 offen offset:3072 lds
	v_mfma_f32_16x16x32_bf16 v[132:135], a[20:23], a[72:75], v[132:135]
	v_mfma_f32_16x16x32_bf16 v[140:143], a[24:27], a[72:75], v[140:143]
	v_mfma_f32_16x16x32_bf16 v[148:151], a[28:31], a[72:75], v[148:151]
	v_mfma_f32_16x16x32_bf16 v[120:123], v[180:183], a[76:79], v[120:123]
	v_mfma_f32_16x16x32_bf16 v[128:131], a[16:19], a[76:79], v[128:131]
	v_mfma_f32_16x16x32_bf16 v[136:139], a[20:23], a[76:79], v[136:139]
	v_mfma_f32_16x16x32_bf16 v[144:147], a[24:27], a[76:79], v[144:147]
	v_mfma_f32_16x16x32_bf16 v[152:155], a[28:31], a[76:79], v[152:155]
	s_waitcnt lgkmcnt(0)
	v_mfma_f32_16x16x32_bf16 v[36:39], a[32:35], v[176:179], v[36:39]
	s_waitcnt vmcnt(8)
	ds_read_b64_tr_b16 a[80:81], v248 offset:16384
	v_mfma_f32_16x16x32_bf16 v[44:47], a[32:35], a[0:3], v[44:47]
	ds_read_b128 v[180:183], v29 offset:0
	ds_read_b64_tr_b16 a[82:83], v248 offset:17408
	v_mfma_f32_16x16x32_bf16 v[52:55], a[32:35], a[4:7], v[52:55]
	ds_read_b64_tr_b16 a[84:85], v249 offset:16384
	v_mfma_f32_16x16x32_bf16 v[60:63], a[32:35], a[8:11], v[60:63]
	ds_read_b64_tr_b16 a[56:57], v30 offset:4096
	ds_read_b64_tr_b16 a[86:87], v249 offset:17408
	v_mfma_f32_16x16x32_bf16 v[68:71], a[32:35], a[12:15], v[68:71]
	ds_read_b64_tr_b16 a[88:89], v248 offset:18432
	v_mfma_f32_16x16x32_bf16 v[40:43], a[36:39], v[176:179], v[40:43]
	ds_read_b64_tr_b16 a[58:59], v30 offset:4608
	v_mfma_f32_16x16x32_bf16 v[48:51], a[36:39], a[0:3], v[48:51]
	ds_read_b64_tr_b16 a[90:91], v248 offset:19456
	ds_read_b128 a[16:19], v27 offset:0
	v_mfma_f32_16x16x32_bf16 v[56:59], a[36:39], a[4:7], v[56:59]
	ds_read_b64_tr_b16 a[92:93], v249 offset:18432
	v_mfma_f32_16x16x32_bf16 v[64:67], a[36:39], a[8:11], v[64:67]
	ds_read_b64_tr_b16 a[94:95], v249 offset:19456
	ds_read_b128 a[20:23], v27 offset:2048
	v_mfma_f32_16x16x32_bf16 v[72:75], a[36:39], a[12:15], v[72:75]
	ds_read_b64_tr_b16 a[96:97], v252 offset:0
	v_mfma_f32_16x16x32_bf16 v[156:159], v[176:179], v[176:179], v[156:159]
	ds_read_b64_tr_b16 a[98:99], v252 offset:1024
	v_mfma_f32_16x16x32_bf16 v[160:163], a[0:3], a[0:3], v[160:163]
	ds_read_b128 a[24:27], v27 offset:4096
	ds_read_b64_tr_b16 a[100:101], v253 offset:0
	v_mfma_f32_16x16x32_bf16 v[164:167], a[4:7], a[4:7], v[164:167]
	ds_read_b64_tr_b16 a[102:103], v253 offset:1024
	v_mfma_f32_16x16x32_bf16 v[168:171], a[8:11], a[8:11], v[168:171]
	ds_read_b128 a[28:31], v27 offset:6144
	ds_read_b64_tr_b16 a[104:105], v252 offset:2048
	v_mfma_f32_16x16x32_bf16 v[172:175], a[12:15], a[12:15], v[172:175]
	ds_read_b64_tr_b16 a[106:107], v252 offset:3072
	v_mfma_f32_16x16x32_bf16 v[76:79], a[40:43], v[176:179], v[76:79]
	ds_read_b64_tr_b16 a[60:61], v31 offset:4096
	v_mfma_f32_16x16x32_bf16 v[84:87], a[40:43], a[0:3], v[84:87]
	ds_read_b64_tr_b16 a[108:109], v253 offset:2048
	ds_read_b64_tr_b16 a[110:111], v253 offset:3072
	v_mfma_f32_16x16x32_bf16 v[92:95], a[40:43], a[4:7], v[92:95]
	ds_read_b64_tr_b16 a[62:63], v31 offset:4608
	s_mul_i32 s82, s72, 2
	s_add_u32 m0, s80, 16384
	v_mfma_f32_16x16x32_bf16 v[100:103], a[40:43], a[8:11], v[100:103]
	ds_read_b64_tr_b16 a[64:65], v30 offset:12288
	s_add_u32 s82, s82, s74
	v_mfma_f32_16x16x32_bf16 v[108:111], a[40:43], a[12:15], v[108:111]
	ds_read_b64_tr_b16 a[66:67], v30 offset:12800
	v_mfma_f32_16x16x32_bf16 v[80:83], a[44:47], v[176:179], v[80:83]
	s_waitcnt lgkmcnt(15)
	buffer_load_dwordx4 v244, s[16:19], s82 offen offset:0 lds
	v_mfma_f32_16x16x32_bf16 v[88:91], a[44:47], a[0:3], v[88:91]
	ds_read_b64_tr_b16 a[68:69], v31 offset:12288
	v_mfma_f32_16x16x32_bf16 v[96:99], a[44:47], a[4:7], v[96:99]
	buffer_load_dwordx4 v245, s[16:19], s82 offen offset:1024 lds
	v_mfma_f32_16x16x32_bf16 v[104:107], a[44:47], a[8:11], v[104:107]
	ds_read_b64_tr_b16 a[70:71], v31 offset:12800
	v_mfma_f32_16x16x32_bf16 v[112:115], a[44:47], a[12:15], v[112:115]
	buffer_load_dwordx4 v246, s[16:19], s82 offen offset:2048 lds
	v_mfma_f32_16x16x32_bf16 v[116:119], v[176:179], a[48:51], v[116:119]
	ds_read_b64_tr_b16 a[72:73], v30 offset:20480
	v_mfma_f32_16x16x32_bf16 v[124:127], a[0:3], a[48:51], v[124:127]
	buffer_load_dwordx4 v247, s[16:19], s82 offen offset:3072 lds
	v_mfma_f32_16x16x32_bf16 v[132:135], a[4:7], a[48:51], v[132:135]
	ds_read_b64_tr_b16 a[74:75], v30 offset:20992
	s_mul_i32 s82, s72, 2
	v_mfma_f32_16x16x32_bf16 v[140:143], a[8:11], a[48:51], v[140:143]
	s_add_u32 m0, s80, 70656
	ds_read_b64_tr_b16 a[76:77], v31 offset:20480
	v_mfma_f32_16x16x32_bf16 v[148:151], a[12:15], a[48:51], v[148:151]
	s_add_u32 s82, s82, s73
	ds_read_b64_tr_b16 a[78:79], v31 offset:20992
	v_mfma_f32_16x16x32_bf16 v[120:123], v[176:179], a[52:55], v[120:123]
	s_waitcnt lgkmcnt(9)
	buffer_load_dwordx4 v244, s[16:19], s82 offen offset:0 lds
	v_mfma_f32_16x16x32_bf16 v[128:131], a[0:3], a[52:55], v[128:131]
	buffer_load_dwordx4 v245, s[16:19], s82 offen offset:1024 lds
	v_mfma_f32_16x16x32_bf16 v[136:139], a[4:7], a[52:55], v[136:139]
	v_mfma_f32_16x16x32_bf16 v[144:147], a[8:11], a[52:55], v[144:147]
	buffer_load_dwordx4 v246, s[16:19], s82 offen offset:2048 lds
	v_mfma_f32_16x16x32_bf16 v[152:155], a[12:15], a[52:55], v[152:155]
	buffer_load_dwordx4 v247, s[16:19], s82 offen offset:3072 lds
	s_waitcnt lgkmcnt(0)
	s_barrier
	v_mfma_f32_16x16x32_bf16 v[36:39], a[56:59], v[180:183], v[36:39]
	s_mul_i32 s82, s72, 3
	s_add_u32 m0, s80, 0
	s_add_u32 s82, s82, s75
	v_mfma_f32_16x16x32_bf16 v[44:47], a[56:59], a[16:19], v[44:47]
	buffer_load_dwordx4 v244, s[16:19], s82 offen offset:0 lds
	v_mfma_f32_16x16x32_bf16 v[52:55], a[56:59], a[20:23], v[52:55]
	buffer_load_dwordx4 v245, s[16:19], s82 offen offset:1024 lds
	v_mfma_f32_16x16x32_bf16 v[60:63], a[56:59], a[24:27], v[60:63]
	v_mfma_f32_16x16x32_bf16 v[68:71], a[56:59], a[28:31], v[68:71]
	buffer_load_dwordx4 v246, s[16:19], s82 offen offset:2048 lds
	v_mfma_f32_16x16x32_bf16 v[40:43], a[60:63], v[180:183], v[40:43]
	buffer_load_dwordx4 v247, s[16:19], s82 offen offset:3072 lds
	v_mfma_f32_16x16x32_bf16 v[48:51], a[60:63], a[16:19], v[48:51]
	s_mul_i32 s82, s72, 3
	v_mfma_f32_16x16x32_bf16 v[56:59], a[60:63], a[20:23], v[56:59]
	s_add_u32 m0, s81, 0
	s_add_u32 s82, s82, s76
	v_mfma_f32_16x16x32_bf16 v[64:67], a[60:63], a[24:27], v[64:67]
	buffer_load_dwordx4 v244, s[16:19], s82 offen offset:0 lds
	v_mfma_f32_16x16x32_bf16 v[72:75], a[60:63], a[28:31], v[72:75]
	buffer_load_dwordx4 v245, s[16:19], s82 offen offset:1024 lds
	v_mfma_f32_16x16x32_bf16 v[156:159], v[180:183], v[180:183], v[156:159]
	v_mfma_f32_16x16x32_bf16 v[160:163], a[16:19], a[16:19], v[160:163]
	buffer_load_dwordx4 v246, s[16:19], s82 offen offset:2048 lds
	v_mfma_f32_16x16x32_bf16 v[164:167], a[20:23], a[20:23], v[164:167]
	buffer_load_dwordx4 v247, s[16:19], s82 offen offset:3072 lds
	v_mfma_f32_16x16x32_bf16 v[168:171], a[24:27], a[24:27], v[168:171]
	s_waitcnt vmcnt(16)
	v_mfma_f32_16x16x32_bf16 v[172:175], a[28:31], a[28:31], v[172:175]
	ds_read_b64_tr_b16 a[112:113], v248 offset:32768
	v_mfma_f32_16x16x32_bf16 v[76:79], a[64:67], v[180:183], v[76:79]
	ds_read_b64_tr_b16 a[114:115], v248 offset:33792
	v_mfma_f32_16x16x32_bf16 v[84:87], a[64:67], a[16:19], v[84:87]
	ds_read_b64_tr_b16 a[116:117], v249 offset:32768
	ds_read_b64_tr_b16 a[118:119], v249 offset:33792
	v_mfma_f32_16x16x32_bf16 v[92:95], a[64:67], a[20:23], v[92:95]
	ds_read_b64_tr_b16 a[120:121], v248 offset:34816
	v_mfma_f32_16x16x32_bf16 v[100:103], a[64:67], a[24:27], v[100:103]
	ds_read_b64_tr_b16 a[122:123], v248 offset:35840
	v_mfma_f32_16x16x32_bf16 v[108:111], a[64:67], a[28:31], v[108:111]
	ds_read_b64_tr_b16 a[124:125], v249 offset:34816
	v_mfma_f32_16x16x32_bf16 v[80:83], a[68:71], v[180:183], v[80:83]
	ds_read_b64_tr_b16 a[126:127], v249 offset:35840
	ds_read_b64_tr_b16 a[128:129], v248 offset:49152
	v_mfma_f32_16x16x32_bf16 v[88:91], a[68:71], a[16:19], v[88:91]
	ds_read_b64_tr_b16 a[130:131], v248 offset:50176
	v_mfma_f32_16x16x32_bf16 v[96:99], a[68:71], a[20:23], v[96:99]
	ds_read_b64_tr_b16 a[132:133], v249 offset:49152
	v_mfma_f32_16x16x32_bf16 v[104:107], a[68:71], a[24:27], v[104:107]
	ds_read_b64_tr_b16 a[134:135], v249 offset:50176
	v_mfma_f32_16x16x32_bf16 v[112:115], a[68:71], a[28:31], v[112:115]
	ds_read_b64_tr_b16 a[136:137], v248 offset:51200
	ds_read_b64_tr_b16 a[138:139], v248 offset:52224
	v_mfma_f32_16x16x32_bf16 v[116:119], v[180:183], a[72:75], v[116:119]
	ds_read_b64_tr_b16 a[140:141], v249 offset:51200
	v_mfma_f32_16x16x32_bf16 v[124:127], a[16:19], a[72:75], v[124:127]
	ds_read_b64_tr_b16 a[142:143], v249 offset:52224
	v_mfma_f32_16x16x32_bf16 v[132:135], a[20:23], a[72:75], v[132:135]
	v_mfma_f32_16x16x32_bf16 v[140:143], a[24:27], a[72:75], v[140:143]
	v_mfma_f32_16x16x32_bf16 v[148:151], a[28:31], a[72:75], v[148:151]
	v_mfma_f32_16x16x32_bf16 v[120:123], v[180:183], a[76:79], v[120:123]
	v_mfma_f32_16x16x32_bf16 v[128:131], a[16:19], a[76:79], v[128:131]
	v_mfma_f32_16x16x32_bf16 v[136:139], a[20:23], a[76:79], v[136:139]
	v_mfma_f32_16x16x32_bf16 v[144:147], a[24:27], a[76:79], v[144:147]
	v_mfma_f32_16x16x32_bf16 v[152:155], a[28:31], a[76:79], v[152:155]
	s_mul_i32 s82, s72, 4
	s_mov_b32 s64, 0x22222222
	s_mov_b32 s65, 0x22222222
	s_mov_b32 s66, 0x44444444
	s_mov_b32 s67, 0x44444444
	s_mov_b32 s68, 0x88888888
	s_mov_b32 s69, 0x88888888
	s_mov_b32 s70, 0x3b124925
	s_add_u32 m0, s80, 32768
	s_mul_i32 s49, s32, 1280
	s_add_u32 s49, s49, 131072
	v_lshl_add_u32 v26, v25, 4, s49
	v_lshl_add_u32 v27, v24, 2, s49
	v_cndmask_b32 v184, v156, v157, s[64:65]
	v_cndmask_b32 v185, v160, v161, s[64:65]
	v_cndmask_b32 v186, v164, v165, s[64:65]
	s_add_u32 s82, s82, s73
	v_cndmask_b32 v187, v168, v169, s[64:65]
	v_cndmask_b32 v188, v172, v173, s[64:65]
	v_cndmask_b32 v184, v184, v158, s[66:67]
	v_cndmask_b32 v185, v185, v162, s[66:67]
	v_cndmask_b32 v186, v186, v166, s[66:67]
	v_cndmask_b32 v187, v187, v170, s[66:67]
	v_cndmask_b32 v188, v188, v174, s[66:67]
	s_waitcnt lgkmcnt(8)
	buffer_load_dwordx4 v244, s[16:19], s82 offen offset:0 lds
	v_cndmask_b32 v184, v184, v159, s[68:69]
	v_cndmask_b32 v185, v185, v163, s[68:69]
	v_cndmask_b32 v186, v186, v167, s[68:69]
	v_cndmask_b32 v187, v187, v171, s[68:69]
	v_cndmask_b32 v188, v188, v175, s[68:69]
	s_mov_b32 exec_lo, 0x10001000
	s_mov_b32 exec_hi, 0x10001000
	ds_write_b128 v26, v[120:123] offset:0
	ds_write_b128 v26, v[128:131] offset:64
	ds_write_b128 v26, v[136:139] offset:128
	ds_write_b128 v26, v[144:147] offset:192
	ds_write_b128 v26, v[152:155] offset:256
	s_mov_b32 exec_lo, 0xf0000f
	s_mov_b32 exec_hi, 0xf0000f00
	ds_write_b32 v27, v184 offset:320
	ds_write_b32 v27, v185 offset:384
	ds_write_b32 v27, v186 offset:448
	ds_write_b32 v27, v187 offset:512
	ds_write_b32 v27, v188 offset:576
	s_mov_b64 exec, -1
	ds_read_b32 v189, v27 offset:0
	buffer_load_dwordx4 v245, s[16:19], s82 offen offset:1024 lds
	ds_read_b32 v194, v27 offset:320
	ds_read_b32 v190, v27 offset:64
	ds_read_b32 v195, v27 offset:384
	ds_read_b32 v191, v27 offset:128
	ds_read_b32 v196, v27 offset:448
	ds_read_b32 v192, v27 offset:192
	ds_read_b32 v197, v27 offset:512
	buffer_load_dwordx4 v246, s[16:19], s82 offen offset:2048 lds
	ds_read_b32 v193, v27 offset:256
	ds_read_b32 v198, v27 offset:576
	v_mov_b32 v199, v116
	v_mov_b32 v184, v116
	v_mov_b32 v200, v120
	v_mov_b32 v185, v120
	v_permlane32_swap_b32 v199, v184
	buffer_load_dwordx4 v247, s[16:19], s82 offen offset:3072 lds
	v_permlane32_swap_b32 v200, v185
	s_waitcnt lgkmcnt(9)
	v_mul_f32 v189, 0xbb124925, v189
	s_waitcnt lgkmcnt(7)
	v_mul_f32 v190, 0xbb124925, v190
	s_waitcnt lgkmcnt(5)
	v_mul_f32 v191, 0xbb124925, v191
	s_waitcnt lgkmcnt(3)
	v_mul_f32 v192, 0xbb124925, v192
	s_waitcnt lgkmcnt(1)
	v_mul_f32 v193, 0xbb124925, v193
	v_mul_f32 v184, v189, v189
	v_mul_f32 v185, v190, v190
	s_mul_i32 s82, s72, 4
	v_mul_f32 v186, v191, v191
	v_mul_f32 v187, v192, v192
	v_mul_f32 v188, v193, v193
	v_fma_f32 v194, v194, s70, -v184
	v_fma_f32 v195, v195, s70, -v185
	v_fma_f32 v196, v196, s70, -v186
	v_fma_f32 v197, v197, s70, -v187
	s_add_u32 m0, s80, 49152
	s_waitcnt lgkmcnt(0)
	v_fma_f32 v198, v198, s70, -v188
	v_max_f32 v194, 0, v194
	v_max_f32 v195, 0, v195
	v_max_f32 v196, 0, v196
	v_max_f32 v197, 0, v197
	v_max_f32 v198, 0, v198
	v_add_f32 v194, 0x3727c5ac, v194
	s_add_u32 s82, s82, s74
	v_add_f32 v195, 0x3727c5ac, v195
	v_add_f32 v196, 0x3727c5ac, v196
	v_add_f32 v197, 0x3727c5ac, v197
	v_add_f32 v198, 0x3727c5ac, v198
	v_rsq_f32 v194, v194
	v_rsq_f32 v195, v195
	v_rsq_f32 v196, v196
	buffer_load_dwordx4 v244, s[16:19], s82 offen offset:0 lds
	v_rsq_f32 v197, v197
	v_rsq_f32 v198, v198
	s_mov_b32 exec_hi, 0
	s_mov_b32 exec_lo, 0xffff
	ds_write_b32 v27, v189 offset:640
	ds_write_b32 v27, v194 offset:960
	ds_write_b32 v27, v190 offset:704
	ds_write_b32 v27, v195 offset:1024
	ds_write_b32 v27, v191 offset:768
	ds_write_b32 v27, v196 offset:1088
	ds_write_b32 v27, v192 offset:832
	ds_write_b32 v27, v197 offset:1152
	ds_write_b32 v27, v193 offset:896
	ds_write_b32 v27, v198 offset:1216
	s_mov_b64 exec, -1
	ds_read_b128 v[156:159], v26 offset:640
	ds_read_b128 v[176:179], v26 offset:960
	ds_read_b128 v[160:163], v26 offset:704
	ds_read_b128 v[180:183], v26 offset:1024
	buffer_load_dwordx4 v245, s[16:19], s82 offen offset:1024 lds
	ds_read_b128 v[164:167], v26 offset:768
	ds_read_b128 v[204:207], v26 offset:1088
	ds_read_b128 v[168:171], v26 offset:832
	ds_read_b128 v[208:211], v26 offset:1152
	ds_read_b128 v[172:175], v26 offset:896
	ds_read_b128 v[212:215], v26 offset:1216
	buffer_load_dwordx4 v246, s[16:19], s82 offen offset:2048 lds
	v_fmac_f32_dpp v44, v36, v190 row_newbcast:0 row_mask:0xf bank_mask:0xf
	v_fmac_f32_dpp v45, v37, v190 row_newbcast:0 row_mask:0xf bank_mask:0xf
	v_fmac_f32_dpp v46, v38, v190 row_newbcast:0 row_mask:0xf bank_mask:0xf
	v_fmac_f32_dpp v47, v39, v190 row_newbcast:0 row_mask:0xf bank_mask:0xf
	v_fmac_f32_dpp v48, v40, v190 row_newbcast:0 row_mask:0xf bank_mask:0xf
	v_fmac_f32_dpp v49, v41, v190 row_newbcast:0 row_mask:0xf bank_mask:0xf
	v_fmac_f32_dpp v50, v42, v190 row_newbcast:0 row_mask:0xf bank_mask:0xf
	buffer_load_dwordx4 v247, s[16:19], s82 offen offset:3072 lds
	v_fmac_f32_dpp v51, v43, v190 row_newbcast:0 row_mask:0xf bank_mask:0xf
	v_fmac_f32_dpp v52, v36, v191 row_newbcast:0 row_mask:0xf bank_mask:0xf
	v_fmac_f32_dpp v53, v37, v191 row_newbcast:0 row_mask:0xf bank_mask:0xf
	v_fmac_f32_dpp v54, v38, v191 row_newbcast:0 row_mask:0xf bank_mask:0xf
	v_fmac_f32_dpp v55, v39, v191 row_newbcast:0 row_mask:0xf bank_mask:0xf
	v_fmac_f32_dpp v56, v40, v191 row_newbcast:0 row_mask:0xf bank_mask:0xf
	v_fmac_f32_dpp v57, v41, v191 row_newbcast:0 row_mask:0xf bank_mask:0xf
	v_fmac_f32_dpp v58, v42, v191 row_newbcast:0 row_mask:0xf bank_mask:0xf
	s_waitcnt vmcnt(16)
	v_fmac_f32_dpp v59, v43, v191 row_newbcast:0 row_mask:0xf bank_mask:0xf
	v_fmac_f32_dpp v60, v36, v192 row_newbcast:0 row_mask:0xf bank_mask:0xf
	v_fmac_f32_dpp v61, v37, v192 row_newbcast:0 row_mask:0xf bank_mask:0xf
	v_fmac_f32_dpp v62, v38, v192 row_newbcast:0 row_mask:0xf bank_mask:0xf
	v_fmac_f32_dpp v63, v39, v192 row_newbcast:0 row_mask:0xf bank_mask:0xf
	v_fmac_f32_dpp v64, v40, v192 row_newbcast:0 row_mask:0xf bank_mask:0xf
	v_fmac_f32_dpp v65, v41, v192 row_newbcast:0 row_mask:0xf bank_mask:0xf
	ds_read_b64_tr_b16 a[160:161], v248 offset:16384
	ds_read_b64_tr_b16 a[162:163], v248 offset:17408
	ds_read_b64_tr_b16 a[164:165], v249 offset:16384
	ds_read_b64_tr_b16 a[166:167], v249 offset:17408
	ds_read_b64_tr_b16 a[168:169], v248 offset:18432
	ds_read_b64_tr_b16 a[170:171], v248 offset:19456
	ds_read_b64_tr_b16 a[172:173], v249 offset:18432
	ds_read_b64_tr_b16 a[174:175], v249 offset:19456
	v_fmac_f32_dpp v66, v42, v192 row_newbcast:0 row_mask:0xf bank_mask:0xf
	v_fmac_f32_dpp v67, v43, v192 row_newbcast:0 row_mask:0xf bank_mask:0xf
	v_fmac_f32_dpp v68, v36, v193 row_newbcast:0 row_mask:0xf bank_mask:0xf
	v_fmac_f32_dpp v69, v37, v193 row_newbcast:0 row_mask:0xf bank_mask:0xf
	v_fmac_f32_dpp v70, v38, v193 row_newbcast:0 row_mask:0xf bank_mask:0xf
	v_fmac_f32_dpp v71, v39, v193 row_newbcast:0 row_mask:0xf bank_mask:0xf
	v_fmac_f32_dpp v72, v40, v193 row_newbcast:0 row_mask:0xf bank_mask:0xf
	ds_read_b64_tr_b16 a[144:145], v252 offset:0
	ds_read_b64_tr_b16 a[146:147], v252 offset:1024
	ds_read_b64_tr_b16 a[148:149], v253 offset:0
	ds_read_b64_tr_b16 a[150:151], v253 offset:1024
	ds_read_b64_tr_b16 a[152:153], v252 offset:2048
	ds_read_b64_tr_b16 a[154:155], v252 offset:3072
	ds_read_b64_tr_b16 a[156:157], v253 offset:2048
	ds_read_b64_tr_b16 a[158:159], v253 offset:3072
	v_fmac_f32_dpp v73, v41, v193 row_newbcast:0 row_mask:0xf bank_mask:0xf
	v_fmac_f32_dpp v74, v42, v193 row_newbcast:0 row_mask:0xf bank_mask:0xf
	v_fmac_f32_dpp v75, v43, v193 row_newbcast:0 row_mask:0xf bank_mask:0xf
	v_fmac_f32_dpp v84, v76, v190 row_newbcast:0 row_mask:0xf bank_mask:0xf
	v_fmac_f32_dpp v85, v77, v190 row_newbcast:0 row_mask:0xf bank_mask:0xf
	v_fmac_f32_dpp v86, v78, v190 row_newbcast:0 row_mask:0xf bank_mask:0xf
	v_fmac_f32_dpp v87, v79, v190 row_newbcast:0 row_mask:0xf bank_mask:0xf
	s_mul_i32 s82, s72, 6
	v_fmac_f32_dpp v88, v80, v190 row_newbcast:0 row_mask:0xf bank_mask:0xf
	v_fmac_f32_dpp v89, v81, v190 row_newbcast:0 row_mask:0xf bank_mask:0xf
	v_fmac_f32_dpp v90, v82, v190 row_newbcast:0 row_mask:0xf bank_mask:0xf
	v_fmac_f32_dpp v91, v83, v190 row_newbcast:0 row_mask:0xf bank_mask:0xf
	v_fmac_f32_dpp v92, v76, v191 row_newbcast:0 row_mask:0xf bank_mask:0xf
	v_fmac_f32_dpp v93, v77, v191 row_newbcast:0 row_mask:0xf bank_mask:0xf
	v_fmac_f32_dpp v94, v78, v191 row_newbcast:0 row_mask:0xf bank_mask:0xf
	s_add_u32 m0, s80, 16384
	v_fmac_f32_dpp v95, v79, v191 row_newbcast:0 row_mask:0xf bank_mask:0xf
	v_fmac_f32_dpp v96, v80, v191 row_newbcast:0 row_mask:0xf bank_mask:0xf
	v_fmac_f32_dpp v97, v81, v191 row_newbcast:0 row_mask:0xf bank_mask:0xf
	v_fmac_f32_dpp v98, v82, v191 row_newbcast:0 row_mask:0xf bank_mask:0xf
	v_fmac_f32_dpp v99, v83, v191 row_newbcast:0 row_mask:0xf bank_mask:0xf
	v_fmac_f32_dpp v100, v76, v192 row_newbcast:0 row_mask:0xf bank_mask:0xf
	v_fmac_f32_dpp v101, v77, v192 row_newbcast:0 row_mask:0xf bank_mask:0xf
	s_add_u32 s82, s82, s74
	v_fmac_f32_dpp v102, v78, v192 row_newbcast:0 row_mask:0xf bank_mask:0xf
	v_fmac_f32_dpp v103, v79, v192 row_newbcast:0 row_mask:0xf bank_mask:0xf
	v_fmac_f32_dpp v104, v80, v192 row_newbcast:0 row_mask:0xf bank_mask:0xf
	v_fmac_f32_dpp v105, v81, v192 row_newbcast:0 row_mask:0xf bank_mask:0xf
	v_fmac_f32_dpp v106, v82, v192 row_newbcast:0 row_mask:0xf bank_mask:0xf
	v_fmac_f32_dpp v107, v83, v192 row_newbcast:0 row_mask:0xf bank_mask:0xf
	v_fmac_f32_dpp v108, v76, v193 row_newbcast:0 row_mask:0xf bank_mask:0xf
	s_waitcnt lgkmcnt(8)
	buffer_load_dwordx4 v244, s[16:19], s82 offen offset:0 lds
	v_fmac_f32_dpp v109, v77, v193 row_newbcast:0 row_mask:0xf bank_mask:0xf
	v_fmac_f32_dpp v110, v78, v193 row_newbcast:0 row_mask:0xf bank_mask:0xf
	v_fmac_f32_dpp v111, v79, v193 row_newbcast:0 row_mask:0xf bank_mask:0xf
	v_fmac_f32_dpp v112, v80, v193 row_newbcast:0 row_mask:0xf bank_mask:0xf
	v_fmac_f32_dpp v113, v81, v193 row_newbcast:0 row_mask:0xf bank_mask:0xf
	v_fmac_f32_dpp v114, v82, v193 row_newbcast:0 row_mask:0xf bank_mask:0xf
	v_fmac_f32_dpp v115, v83, v193 row_newbcast:0 row_mask:0xf bank_mask:0xf
	v_fmac_f32_dpp v76, v76, v189 row_newbcast:0 row_mask:0xf bank_mask:0xf
	buffer_load_dwordx4 v245, s[16:19], s82 offen offset:1024 lds
	v_fmac_f32_dpp v77, v77, v189 row_newbcast:0 row_mask:0xf bank_mask:0xf
	v_fmac_f32_dpp v78, v78, v189 row_newbcast:0 row_mask:0xf bank_mask:0xf
	v_fmac_f32_dpp v79, v79, v189 row_newbcast:0 row_mask:0xf bank_mask:0xf
	v_fmac_f32_dpp v80, v80, v189 row_newbcast:0 row_mask:0xf bank_mask:0xf
	v_fmac_f32_dpp v81, v81, v189 row_newbcast:0 row_mask:0xf bank_mask:0xf
	v_fmac_f32_dpp v82, v82, v189 row_newbcast:0 row_mask:0xf bank_mask:0xf
	v_fmac_f32_dpp v83, v83, v189 row_newbcast:0 row_mask:0xf bank_mask:0xf
	buffer_load_dwordx4 v246, s[16:19], s82 offen offset:2048 lds
	v_cvt_pk_bf16_f32 v44, v44, v45
	v_cvt_pk_bf16_f32 v45, v46, v47
	v_cvt_pk_bf16_f32 v46, v48, v49
	v_cvt_pk_bf16_f32 v47, v50, v51
	v_cvt_pk_bf16_f32 v52, v52, v53
	v_cvt_pk_bf16_f32 v53, v54, v55
	v_cvt_pk_bf16_f32 v54, v56, v57
	buffer_load_dwordx4 v247, s[16:19], s82 offen offset:3072 lds
	v_cvt_pk_bf16_f32 v55, v58, v59
	v_cvt_pk_bf16_f32 v60, v60, v61
	v_cvt_pk_bf16_f32 v61, v62, v63
	v_cvt_pk_bf16_f32 v62, v64, v65
	v_cvt_pk_bf16_f32 v63, v66, v67
	v_cvt_pk_bf16_f32 v68, v68, v69
	v_cvt_pk_bf16_f32 v69, v70, v71
	s_mul_i32 s82, s72, 5
	v_cvt_pk_bf16_f32 v70, v72, v73
	v_cvt_pk_bf16_f32 v71, v74, v75
	v_cvt_pk_bf16_f32 v76, v76, v77
	v_cvt_pk_bf16_f32 v77, v78, v79
	v_cvt_pk_bf16_f32 v78, v80, v81
	v_cvt_pk_bf16_f32 v79, v82, v83
	v_cvt_pk_bf16_f32 v84, v84, v85
	s_add_u32 m0, s80, 70656
	v_cvt_pk_bf16_f32 v85, v86, v87
	v_cvt_pk_bf16_f32 v86, v88, v89
	v_cvt_pk_bf16_f32 v87, v90, v91
	v_cvt_pk_bf16_f32 v92, v92, v93
	v_cvt_pk_bf16_f32 v93, v94, v95
	v_cvt_pk_bf16_f32 v94, v96, v97
	v_cvt_pk_bf16_f32 v95, v98, v99
	s_add_u32 s82, s82, s75
	v_cvt_pk_bf16_f32 v100, v100, v101
	v_cvt_pk_bf16_f32 v101, v102, v103
	v_cvt_pk_bf16_f32 v102, v104, v105
	v_cvt_pk_bf16_f32 v103, v106, v107
	v_cvt_pk_bf16_f32 v108, v108, v109
	v_cvt_pk_bf16_f32 v109, v110, v111
	v_cvt_pk_bf16_f32 v110, v112, v113
	s_waitcnt lgkmcnt(0)
	buffer_load_dwordx4 v244, s[16:19], s82 offen offset:0 lds
	v_cvt_pk_bf16_f32 v111, v114, v115
	v_pk_fma_f32 v[116:117], v[156:157], v[198:199], v[116:117] op_sel:[0,1,0]
	v_pk_fma_f32 v[118:119], v[158:159], v[198:199], v[118:119] op_sel:[0,1,0]
	v_pk_fma_f32 v[120:121], v[156:157], v[200:201], v[120:121] op_sel_hi:[1,0,1]
	v_pk_fma_f32 v[122:123], v[158:159], v[200:201], v[122:123] op_sel_hi:[1,0,1]
	v_pk_fma_f32 v[124:125], v[160:161], v[198:199], v[124:125] op_sel:[0,1,0]
	v_pk_fma_f32 v[126:127], v[162:163], v[198:199], v[126:127] op_sel:[0,1,0]
	v_pk_fma_f32 v[128:129], v[160:161], v[200:201], v[128:129] op_sel_hi:[1,0,1]
	buffer_load_dwordx4 v245, s[16:19], s82 offen offset:1024 lds
	v_pk_fma_f32 v[130:131], v[162:163], v[200:201], v[130:131] op_sel_hi:[1,0,1]
	v_pk_fma_f32 v[132:133], v[164:165], v[198:199], v[132:133] op_sel:[0,1,0]
	v_pk_fma_f32 v[134:135], v[166:167], v[198:199], v[134:135] op_sel:[0,1,0]
	v_pk_fma_f32 v[136:137], v[164:165], v[200:201], v[136:137] op_sel_hi:[1,0,1]
	v_pk_fma_f32 v[138:139], v[166:167], v[200:201], v[138:139] op_sel_hi:[1,0,1]
	v_pk_fma_f32 v[140:141], v[168:169], v[198:199], v[140:141] op_sel:[0,1,0]
	v_pk_fma_f32 v[142:143], v[170:171], v[198:199], v[142:143] op_sel:[0,1,0]
	buffer_load_dwordx4 v246, s[16:19], s82 offen offset:2048 lds
	v_pk_fma_f32 v[144:145], v[168:169], v[200:201], v[144:145] op_sel_hi:[1,0,1]
	v_pk_fma_f32 v[146:147], v[170:171], v[200:201], v[146:147] op_sel_hi:[1,0,1]
	v_pk_fma_f32 v[148:149], v[172:173], v[198:199], v[148:149] op_sel:[0,1,0]
	v_pk_fma_f32 v[150:151], v[174:175], v[198:199], v[150:151] op_sel:[0,1,0]
	v_pk_fma_f32 v[152:153], v[172:173], v[200:201], v[152:153] op_sel_hi:[1,0,1]
	v_pk_fma_f32 v[154:155], v[174:175], v[200:201], v[154:155] op_sel_hi:[1,0,1]
	v_mfma_f32_16x16x32_bf16 v[48:51], v[76:79], v[44:47], 0
	buffer_load_dwordx4 v247, s[16:19], s82 offen offset:3072 lds
	v_mfma_f32_16x16x32_bf16 v[88:91], v[84:87], v[44:47], 0
	v_mfma_f32_16x16x32_bf16 v[56:59], v[84:87], v[52:55], 0
	v_mfma_f32_16x16x32_bf16 v[96:99], v[92:95], v[52:55], 0
	v_mfma_f32_16x16x32_bf16 v[64:67], v[92:95], v[60:63], 0
	v_mfma_f32_16x16x32_bf16 v[104:107], v[100:103], v[60:63], 0
	v_mfma_f32_16x16x32_bf16 v[72:75], v[100:103], v[68:71], 0
	v_mfma_f32_16x16x32_bf16 v[112:115], v[108:111], v[68:71], 0
	s_mul_i32 s82, s77, 28672
	v_cvt_pk_bf16_f32 v216, v116, v117
	v_cvt_pk_bf16_f32 v217, v118, v119
	v_cvt_pk_bf16_f32 v218, v124, v125
	v_cvt_pk_bf16_f32 v219, v126, v127
	v_cvt_pk_bf16_f32 v220, v132, v133
	v_cvt_pk_bf16_f32 v221, v134, v135
	s_add_u32 m0, s81, 4096
	v_cvt_pk_bf16_f32 v222, v140, v141
	v_cvt_pk_bf16_f32 v223, v142, v143
	v_cvt_pk_bf16_f32 v224, v148, v149
	v_cvt_pk_bf16_f32 v225, v150, v151
	v_cvt_pk_bf16_f32 v226, v120, v121
	v_cvt_pk_bf16_f32 v227, v122, v123
	v_cvt_pk_bf16_f32 v228, v128, v129
	s_add_u32 s82, s82, s83
	v_cvt_pk_bf16_f32 v229, v130, v131
	v_cvt_pk_bf16_f32 v230, v136, v137
	v_cvt_pk_bf16_f32 v231, v138, v139
	v_cvt_pk_bf16_f32 v232, v144, v145
	v_cvt_pk_bf16_f32 v233, v146, v147
	v_cvt_pk_bf16_f32 v234, v152, v153
	v_cvt_pk_bf16_f32 v235, v154, v155
	buffer_load_dwordx4 v244, s[16:19], s82 offen offset:0 lds
	v_mov_b32 v3, 0xf149f2ca
	v_lshlrev_b32 v4, 2, v25
	v_sub_u32 v4, v24, v4
	v_subrev_u32 v5, 0, v4
	v_cmp_ge_u32 vcc, 7, v5
	s_nop 1
	v_cndmask_b32 v36, v3, v16, vcc
	v_cmp_ge_i32 vcc, -9, v5
	buffer_load_dwordx4 v245, s[16:19], s82 offen offset:1024 lds
	s_nop 0
	v_cndmask_b32 v40, v3, v16, vcc
	v_subrev_u32 v5, 1, v4
	v_cmp_ge_u32 vcc, 7, v5
	s_nop 1
	v_cndmask_b32 v37, v3, v16, vcc
	v_cmp_ge_i32 vcc, -9, v5
	s_nop 1
	v_cndmask_b32 v41, v3, v16, vcc
	v_subrev_u32 v5, 2, v4
	buffer_load_dwordx4 v246, s[16:19], s82 offen offset:2048 lds
	v_cmp_ge_u32 vcc, 7, v5
	s_nop 1
	v_cndmask_b32 v38, v3, v16, vcc
	v_cmp_ge_i32 vcc, -9, v5
	s_nop 1
	v_cndmask_b32 v42, v3, v16, vcc
	v_subrev_u32 v5, 3, v4
	v_cmp_ge_u32 vcc, 7, v5
	s_nop 1
	v_cndmask_b32 v39, v3, v16, vcc
	buffer_load_dwordx4 v247, s[16:19], s82 offen offset:3072 lds
	v_cmp_ge_i32 vcc, -9, v5
	s_nop 1
	v_cndmask_b32 v43, v3, v16, vcc
	s_cmp_eq_u32 s33, 0
	s_cselect_b32 s71, 0xf149f2ca, 0
	v_add_f32 v80, s71, v40
	v_add_f32 v81, s71, v41
	v_add_f32 v82, s71, v42
	v_add_f32 v83, s71, v43
	s_mul_i32 s82, s78, 28672
	v_pk_fma_f32 v[48:49], v[48:49], v[176:177], v[80:81]
	v_pk_fma_f32 v[50:51], v[50:51], v[178:179], v[82:83]
	v_pk_fma_f32 v[88:89], v[88:89], v[180:181], v[36:37]
	v_pk_fma_f32 v[90:91], v[90:91], v[182:183], v[38:39]
	v_pk_fma_f32 v[56:57], v[56:57], v[180:181], v[40:41]
	v_pk_fma_f32 v[58:59], v[58:59], v[182:183], v[42:43]
	s_add_u32 m0, s81, 8192
	v_pk_fma_f32 v[96:97], v[96:97], v[204:205], v[36:37]
	v_pk_fma_f32 v[98:99], v[98:99], v[206:207], v[38:39]
	v_pk_fma_f32 v[64:65], v[64:65], v[204:205], v[40:41]
	v_pk_fma_f32 v[66:67], v[66:67], v[206:207], v[42:43]
	v_pk_fma_f32 v[104:105], v[104:105], v[208:209], v[36:37]
	v_pk_fma_f32 v[106:107], v[106:107], v[210:211], v[38:39]
	v_pk_fma_f32 v[72:73], v[72:73], v[208:209], v[40:41]
	s_add_u32 s82, s82, s83
	v_pk_fma_f32 v[74:75], v[74:75], v[210:211], v[42:43]
	v_pk_fma_f32 v[112:113], v[112:113], v[212:213], v[36:37]
	v_pk_fma_f32 v[114:115], v[114:115], v[214:215], v[38:39]
	v_max3_f32 v185, v48, v49, v50
	v_max3_f32 v186, v56, v57, v58
	v_max3_f32 v187, v64, v65, v66
	v_max3_f32 v188, v72, v73, v74
	buffer_load_dwordx4 v244, s[16:19], s82 offen offset:0 lds
	v_max3_f32 v185, v185, v51, v88
	v_max3_f32 v186, v186, v59, v96
	v_max3_f32 v187, v187, v67, v104
	v_max3_f32 v188, v188, v75, v112
	v_max3_f32 v185, v185, v89, v90
	v_max3_f32 v186, v186, v97, v98
	v_max3_f32 v187, v187, v105, v106
	v_max3_f32 v188, v188, v113, v114
	buffer_load_dwordx4 v245, s[16:19], s82 offen offset:1024 lds
	v_max_f32 v185, v185, v91
	v_max_f32 v186, v186, v99
	v_max_f32 v187, v187, v107
	v_max_f32 v188, v188, v115
	v_mov_b32 v236, v185
	v_mov_b32 v237, v186
	v_mov_b32 v238, v187
	buffer_load_dwordx4 v246, s[16:19], s82 offen offset:2048 lds
	v_mov_b32 v239, v188
	v_permlane16_swap_b32 v185, v236
	v_permlane16_swap_b32 v186, v237
	v_permlane16_swap_b32 v187, v238
	v_permlane16_swap_b32 v188, v239
	v_max_f32 v185, v185, v236
	v_max_f32 v186, v186, v237
	buffer_load_dwordx4 v247, s[16:19], s82 offen offset:3072 lds
	v_max_f32 v187, v187, v238
	v_max_f32 v188, v188, v239
	v_mov_b32 v236, v185
	v_mov_b32 v237, v186
	v_mov_b32 v238, v187
	v_mov_b32 v239, v188
	v_permlane32_swap_b32 v185, v236
	s_waitcnt vmcnt(24)
	v_permlane32_swap_b32 v186, v237
	v_permlane32_swap_b32 v187, v238
	v_permlane32_swap_b32 v188, v239
	v_max_f32 v185, v185, v236
	v_max_f32 v186, v186, v237
	v_max_f32 v187, v187, v238
	v_max_f32 v188, v188, v239
	ds_read_b64_tr_b16 a[176:177], v248 offset:0
	ds_read_b64_tr_b16 a[178:179], v248 offset:1024
	ds_read_b64_tr_b16 a[180:181], v249 offset:0
	ds_read_b64_tr_b16 a[182:183], v249 offset:1024
	ds_read_b64_tr_b16 a[184:185], v248 offset:2048
	ds_read_b64_tr_b16 a[186:187], v248 offset:3072
	ds_read_b64_tr_b16 a[188:189], v249 offset:2048
	ds_read_b64_tr_b16 a[190:191], v249 offset:3072
	v_mul_f32 v195, 0x3e8b97f6, v195
	v_mul_f32 v196, 0x3e8b97f6, v196
	v_mul_f32 v197, 0x3e8b97f6, v197
	v_mul_f32 v198, 0x3e8b97f6, v198
	v_mul_f32 v185, v185, v195
	v_mul_f32 v186, v186, v196
	v_mul_f32 v187, v187, v197
	ds_read_b64_tr_b16 a[192:193], v250 offset:0
	ds_read_b64_tr_b16 a[194:195], v250 offset:1024
	ds_read_b64_tr_b16 a[196:197], v251 offset:0
	ds_read_b64_tr_b16 a[198:199], v251 offset:1024
	ds_read_b64_tr_b16 a[200:201], v250 offset:2048
	ds_read_b64_tr_b16 a[202:203], v250 offset:3072
	ds_read_b64_tr_b16 a[204:205], v251 offset:2048
	ds_read_b64_tr_b16 a[206:207], v251 offset:3072
	v_mul_f32 v188, v188, v198
	v_pk_fma_f32 v[48:49], v[48:49], v[194:195], v[184:185] op_sel:[0,1,1] neg_lo:[0,0,1] neg_hi:[0,0,1]
	v_pk_fma_f32 v[88:89], v[88:89], v[194:195], v[184:185] op_sel:[0,1,1] neg_lo:[0,0,1] neg_hi:[0,0,1]
	v_pk_fma_f32 v[50:51], v[50:51], v[194:195], v[184:185] op_sel:[0,1,1] neg_lo:[0,0,1] neg_hi:[0,0,1]
	v_pk_fma_f32 v[90:91], v[90:91], v[194:195], v[184:185] op_sel:[0,1,1] neg_lo:[0,0,1] neg_hi:[0,0,1]
	v_pk_fma_f32 v[56:57], v[56:57], v[196:197], v[186:187] op_sel_hi:[1,0,0] neg_lo:[0,0,1] neg_hi:[0,0,1]
	v_pk_fma_f32 v[96:97], v[96:97], v[196:197], v[186:187] op_sel_hi:[1,0,0] neg_lo:[0,0,1] neg_hi:[0,0,1]
	s_mul_i32 s82, s79, 28672
	v_pk_fma_f32 v[58:59], v[58:59], v[196:197], v[186:187] op_sel_hi:[1,0,0] neg_lo:[0,0,1] neg_hi:[0,0,1]
	v_pk_fma_f32 v[98:99], v[98:99], v[196:197], v[186:187] op_sel_hi:[1,0,0] neg_lo:[0,0,1] neg_hi:[0,0,1]
	v_pk_fma_f32 v[64:65], v[64:65], v[196:197], v[186:187] op_sel:[0,1,1] neg_lo:[0,0,1] neg_hi:[0,0,1]
	v_pk_fma_f32 v[104:105], v[104:105], v[196:197], v[186:187] op_sel:[0,1,1] neg_lo:[0,0,1] neg_hi:[0,0,1]
	v_pk_fma_f32 v[66:67], v[66:67], v[196:197], v[186:187] op_sel:[0,1,1] neg_lo:[0,0,1] neg_hi:[0,0,1]
	v_pk_fma_f32 v[106:107], v[106:107], v[196:197], v[186:187] op_sel:[0,1,1] neg_lo:[0,0,1] neg_hi:[0,0,1]
	v_pk_fma_f32 v[72:73], v[72:73], v[198:199], v[188:189] op_sel_hi:[1,0,0] neg_lo:[0,0,1] neg_hi:[0,0,1]
	v_pk_fma_f32 v[112:113], v[112:113], v[198:199], v[188:189] op_sel_hi:[1,0,0] neg_lo:[0,0,1] neg_hi:[0,0,1]
	s_add_u32 m0, s81, 12288
	v_pk_fma_f32 v[74:75], v[74:75], v[198:199], v[188:189] op_sel_hi:[1,0,0] neg_lo:[0,0,1] neg_hi:[0,0,1]
	v_pk_fma_f32 v[114:115], v[114:115], v[198:199], v[188:189] op_sel_hi:[1,0,0] neg_lo:[0,0,1] neg_hi:[0,0,1]
	v_exp_f32 v48, v48
	v_exp_f32 v88, v88
	v_exp_f32 v49, v49
	v_exp_f32 v89, v89
	v_exp_f32 v50, v50
	s_add_u32 s82, s82, s83
	v_exp_f32 v90, v90
	v_exp_f32 v51, v51
	v_exp_f32 v91, v91
	v_exp_f32 v56, v56
	v_exp_f32 v96, v96
	v_exp_f32 v57, v57
	v_exp_f32 v97, v97
	buffer_load_dwordx4 v244, s[16:19], s82 offen offset:0 lds
	v_exp_f32 v58, v58
	v_exp_f32 v98, v98
	v_exp_f32 v59, v59
	v_exp_f32 v99, v99
	v_exp_f32 v64, v64
	v_exp_f32 v104, v104
	v_exp_f32 v65, v65
	buffer_load_dwordx4 v245, s[16:19], s82 offen offset:1024 lds
	v_exp_f32 v105, v105
	v_exp_f32 v66, v66
	v_exp_f32 v106, v106
	v_exp_f32 v67, v67
	v_exp_f32 v107, v107
	v_exp_f32 v72, v72
	v_exp_f32 v112, v112
	buffer_load_dwordx4 v246, s[16:19], s82 offen offset:2048 lds
	v_exp_f32 v73, v73
	v_exp_f32 v113, v113
	v_exp_f32 v74, v74
	v_exp_f32 v114, v114
	v_exp_f32 v75, v75
	v_exp_f32 v115, v115
	v_pk_add_f32 v[44:45], v[48:49], v[50:51]
	buffer_load_dwordx4 v247, s[16:19], s82 offen offset:3072 lds
	v_pk_add_f32 v[52:53], v[56:57], v[58:59]
	v_pk_add_f32 v[60:61], v[64:65], v[66:67]
	v_pk_add_f32 v[68:69], v[72:73], v[74:75]
	v_pk_add_f32 v[44:45], v[44:45], v[88:89]
	v_pk_add_f32 v[52:53], v[52:53], v[96:97]
	v_pk_add_f32 v[60:61], v[60:61], v[104:105]
	v_pk_add_f32 v[68:69], v[68:69], v[112:113]
	s_mul_i32 s82, s72, 6
	v_pk_add_f32 v[44:45], v[44:45], v[90:91]
	v_pk_add_f32 v[52:53], v[52:53], v[98:99]
	v_pk_add_f32 v[60:61], v[60:61], v[106:107]
	v_pk_add_f32 v[68:69], v[68:69], v[114:115]
	v_add_f32 v185, v44, v45
	v_add_f32 v186, v52, v53
	v_add_f32 v187, v60, v61
	v_add_f32 v188, v68, v69
	s_add_u32 m0, s80, 0
	v_pk_mul_f32 v[48:49], v[48:49], v[176:177]
	v_pk_mul_f32 v[88:89], v[88:89], v[180:181]
	v_pk_mul_f32 v[50:51], v[50:51], v[178:179]
	v_pk_mul_f32 v[90:91], v[90:91], v[182:183]
	v_pk_mul_f32 v[56:57], v[56:57], v[180:181]
	v_pk_mul_f32 v[96:97], v[96:97], v[204:205]
	v_pk_mul_f32 v[58:59], v[58:59], v[182:183]
	s_add_u32 s82, s82, s73
	v_pk_mul_f32 v[98:99], v[98:99], v[206:207]
	v_pk_mul_f32 v[64:65], v[64:65], v[204:205]
	v_pk_mul_f32 v[104:105], v[104:105], v[208:209]
	v_pk_mul_f32 v[66:67], v[66:67], v[206:207]
	v_pk_mul_f32 v[106:107], v[106:107], v[210:211]
	v_pk_mul_f32 v[72:73], v[72:73], v[208:209]
	v_pk_mul_f32 v[112:113], v[112:113], v[212:213]
	s_waitcnt lgkmcnt(8)
	buffer_load_dwordx4 v244, s[16:19], s82 offen offset:0 lds
	v_pk_mul_f32 v[74:75], v[74:75], v[210:211]
	v_pk_mul_f32 v[114:115], v[114:115], v[214:215]
	v_cvt_pk_bf16_f32 v48, v48, v49
	v_cvt_pk_bf16_f32 v49, v50, v51
	v_cvt_pk_bf16_f32 v50, v88, v89
	v_cvt_pk_bf16_f32 v51, v90, v91
	v_cvt_pk_bf16_f32 v56, v56, v57
	buffer_load_dwordx4 v245, s[16:19], s82 offen offset:1024 lds
	v_cvt_pk_bf16_f32 v57, v58, v59
	v_cvt_pk_bf16_f32 v58, v96, v97
	v_cvt_pk_bf16_f32 v59, v98, v99
	v_cvt_pk_bf16_f32 v64, v64, v65
	v_cvt_pk_bf16_f32 v65, v66, v67
	v_cvt_pk_bf16_f32 v66, v104, v105
	v_cvt_pk_bf16_f32 v67, v106, v107
	buffer_load_dwordx4 v246, s[16:19], s82 offen offset:2048 lds
	v_cvt_pk_bf16_f32 v72, v72, v73
	v_cvt_pk_bf16_f32 v73, v74, v75
	v_cvt_pk_bf16_f32 v74, v112, v113
	v_cvt_pk_bf16_f32 v75, v114, v115
	v_mfma_f32_16x16x32_bf16 v[124:127], v[216:219], v[48:51], 0
	v_mfma_f32_16x16x32_bf16 v[128:131], v[226:229], v[48:51], 0
	v_mfma_f32_16x16x32_bf16 v[132:135], v[218:221], v[56:59], 0
	buffer_load_dwordx4 v247, s[16:19], s82 offen offset:3072 lds
	v_mfma_f32_16x16x32_bf16 v[136:139], v[228:231], v[56:59], 0
	v_mfma_f32_16x16x32_bf16 v[140:143], v[220:223], v[64:67], 0
	v_mfma_f32_16x16x32_bf16 v[144:147], v[230:233], v[64:67], 0
	v_mfma_f32_16x16x32_bf16 v[148:151], v[222:225], v[72:75], 0
	v_mfma_f32_16x16x32_bf16 v[152:155], v[232:235], v[72:75], 0
	v_mov_b32 v236, v185
	v_mov_b32 v237, v186
	s_mul_i32 s82, s72, 7
	v_mov_b32 v238, v187
	v_mov_b32 v239, v188
	v_permlane16_swap_b32 v185, v236
	v_permlane16_swap_b32 v186, v237
	v_permlane16_swap_b32 v187, v238
	v_permlane16_swap_b32 v188, v239
	v_add_f32 v185, v185, v236
	v_add_f32 v186, v186, v237
	s_add_u32 m0, s81, 0
	v_add_f32 v187, v187, v238
	v_add_f32 v188, v188, v239
	v_mov_b32 v236, v185
	v_mov_b32 v237, v186
	v_mov_b32 v238, v187
	v_mov_b32 v239, v188
	v_permlane32_swap_b32 v185, v236
	s_add_u32 s82, s82, s76
	v_permlane32_swap_b32 v186, v237
	v_permlane32_swap_b32 v187, v238
	v_permlane32_swap_b32 v188, v239
	v_add_f32 v185, v185, v236
	v_add_f32 v186, v186, v237
	v_add_f32 v187, v187, v238
	v_add_f32 v188, v188, v239
	s_waitcnt lgkmcnt(0)
	buffer_load_dwordx4 v244, s[16:19], s82 offen offset:0 lds
	v_rcp_f32 v185, v185
	v_rcp_f32 v186, v186
	v_rcp_f32 v187, v187
	v_rcp_f32 v188, v188
	v_mul_f32 v185, 0x3f317218, v185
	v_mul_f32 v186, 0x3f317218, v186
	v_mul_f32 v187, 0x3f317218, v187
	buffer_load_dwordx4 v245, s[16:19], s82 offen offset:1024 lds
	v_mul_f32 v188, 0x3f317218, v188
	v_cmp_eq_u32 vcc, 3, v25
	s_nop 1
	v_cndmask_b32 v236, v185, v16, vcc
	v_cndmask_b32 v237, v186, v16, vcc
	v_cndmask_b32 v238, v187, v16, vcc
	v_cndmask_b32 v239, v188, v16, vcc
	v_pk_mul_f32 v[124:125], v[124:125], v[184:185] op_sel:[0,1]
	buffer_load_dwordx4 v246, s[16:19], s82 offen offset:2048 lds
	v_pk_mul_f32 v[128:129], v[128:129], v[236:237] op_sel_hi:[1,0]
	v_pk_mul_f32 v[126:127], v[126:127], v[184:185] op_sel:[0,1]
	v_pk_mul_f32 v[130:131], v[130:131], v[236:237] op_sel_hi:[1,0]
	v_pk_mul_f32 v[132:133], v[132:133], v[186:187] op_sel_hi:[1,0]
	v_pk_mul_f32 v[136:137], v[136:137], v[236:237] op_sel:[0,1]
	v_pk_mul_f32 v[134:135], v[134:135], v[186:187] op_sel_hi:[1,0]
	v_pk_mul_f32 v[138:139], v[138:139], v[236:237] op_sel:[0,1]
	buffer_load_dwordx4 v247, s[16:19], s82 offen offset:3072 lds
	v_pk_mul_f32 v[140:141], v[140:141], v[186:187] op_sel:[0,1]
	v_pk_mul_f32 v[144:145], v[144:145], v[238:239] op_sel_hi:[1,0]
	v_pk_mul_f32 v[142:143], v[142:143], v[186:187] op_sel:[0,1]
	v_pk_mul_f32 v[146:147], v[146:147], v[238:239] op_sel_hi:[1,0]
	v_pk_mul_f32 v[148:149], v[148:149], v[188:189] op_sel_hi:[1,0]
	v_pk_mul_f32 v[152:153], v[152:153], v[238:239] op_sel:[0,1]
	v_pk_mul_f32 v[150:151], v[150:151], v[188:189] op_sel_hi:[1,0]
	v_pk_mul_f32 v[154:155], v[154:155], v[238:239] op_sel:[0,1]
	s_lshl_b32 s49, s33, 17
	s_lshl_b32 s50, s34, 1
	s_add_u32 s50, s50, s40
	s_lshl_b32 s50, s50, 12
	s_add_u32 s49, s49, s50
	s_lshl_b32 s50, s41, 10
	s_add_u32 s49, s49, s50
	s_add_u32 s48, s49, 7340032
	v_and_b32 v28, 15, v0
	v_lshrrev_b32 v4, 5, v0
	v_lshl_or_b32 v28, v4, 4, v28
	v_lshrrev_b32 v4, 4, v0
	v_and_b32 v4, 1, v4
	v_lshl_or_b32 v28, v4, 5, v28
	v_lshlrev_b32 v28, 4, v28
	v_cvt_pk_bf16_f32 v48, v124, v125
	v_cvt_pk_bf16_f32 v49, v126, v127
	v_cvt_pk_bf16_f32 v50, v132, v133
	v_cvt_pk_bf16_f32 v51, v134, v135
	s_nop 0
	v_permlane32_swap_b32 v48, v50
	v_permlane32_swap_b32 v49, v51
	s_add_u32 s47, s48, 0
	buffer_store_dwordx4 v[48:51], v28, s[12:15], s47 offen sc1
	v_cvt_pk_bf16_f32 v88, v128, v129
	v_cvt_pk_bf16_f32 v89, v130, v131
	v_cvt_pk_bf16_f32 v90, v136, v137
	v_cvt_pk_bf16_f32 v91, v138, v139
	s_nop 0
	v_permlane32_swap_b32 v88, v90
	v_permlane32_swap_b32 v89, v91
	s_add_u32 s47, s48, 2048
	buffer_store_dwordx4 v[88:91], v28, s[12:15], s47 offen sc1
	v_cvt_pk_bf16_f32 v64, v140, v141
	v_cvt_pk_bf16_f32 v65, v142, v143
	v_cvt_pk_bf16_f32 v66, v148, v149
	v_cvt_pk_bf16_f32 v67, v150, v151
	s_nop 0
	v_permlane32_swap_b32 v64, v66
	v_permlane32_swap_b32 v65, v67
	s_add_u32 s47, s48, 65536
	buffer_store_dwordx4 v[64:67], v28, s[12:15], s47 offen sc1
	v_cvt_pk_bf16_f32 v104, v144, v145
	v_cvt_pk_bf16_f32 v105, v146, v147
	v_cvt_pk_bf16_f32 v106, v152, v153
	v_cvt_pk_bf16_f32 v107, v154, v155
	s_nop 0
	v_permlane32_swap_b32 v104, v106
	v_permlane32_swap_b32 v105, v107
	s_add_u32 s47, s48, 67584
	buffer_store_dwordx4 v[104:107], v28, s[12:15], s47 offen sc1
	s_waitcnt vmcnt(0)
	v_readfirstlane_b32 s51, v243
	s_cmp_lg_u32 s51, 0
	s_cbranch_scc0 L_rdya_slow
L_rdya_back:
	v_mov_b32 v243, 1
	buffer_atomic_add v243, v240, s[12:15], 0 offen offset:512 sc1
	s_cmp_ge_u32 s3, 28
	s_cbranch_scc1 L_f_done
	buffer_load_dword v242, v241, s[12:15], 0 offen sc1
	ds_read_b64_tr_b16 a[208:209], v248 offset:32768
	ds_read_b64_tr_b16 a[210:211], v248 offset:33792
	ds_read_b64_tr_b16 a[212:213], v249 offset:32768
	ds_read_b64_tr_b16 a[214:215], v249 offset:33792
	ds_read_b64_tr_b16 a[216:217], v248 offset:34816
	ds_read_b64_tr_b16 a[218:219], v248 offset:35840
	ds_read_b64_tr_b16 a[220:221], v249 offset:34816
	ds_read_b64_tr_b16 a[222:223], v249 offset:35840
	ds_read_b64_tr_b16 a[224:225], v248 offset:49152
	ds_read_b64_tr_b16 a[226:227], v248 offset:50176
	ds_read_b64_tr_b16 a[228:229], v249 offset:49152
	ds_read_b64_tr_b16 a[230:231], v249 offset:50176
	ds_read_b64_tr_b16 a[232:233], v248 offset:51200
	ds_read_b64_tr_b16 a[234:235], v248 offset:52224
	ds_read_b64_tr_b16 a[236:237], v249 offset:51200
	ds_read_b64_tr_b16 a[238:239], v249 offset:52224
	ds_read_b64_tr_b16 a[240:241], v252 offset:0
	ds_read_b64_tr_b16 a[242:243], v252 offset:1024
	ds_read_b64_tr_b16 a[244:245], v253 offset:0
	ds_read_b64_tr_b16 a[246:247], v253 offset:1024
	ds_read_b64_tr_b16 a[248:249], v252 offset:2048
	ds_read_b64_tr_b16 a[250:251], v252 offset:3072
	buffer_load_dword v216, v241, s[12:15], 0 offen sc1
	ds_read_b64_tr_b16 a[252:253], v253 offset:2048
	ds_read_b64_tr_b16 a[254:255], v253 offset:3072
	s_mul_i32 s82, s72, 7
	s_add_u32 m0, s80, 32768
	s_add_u32 s82, s82, s75
	s_waitcnt lgkmcnt(15)
	buffer_load_dwordx4 v244, s[16:19], s82 offen offset:0 lds
	buffer_load_dwordx4 v245, s[16:19], s82 offen offset:1024 lds
	buffer_load_dwordx4 v246, s[16:19], s82 offen offset:2048 lds
	buffer_load_dwordx4 v247, s[16:19], s82 offen offset:3072 lds
	s_mul_i32 s82, s72, 5
	s_add_u32 m0, s80, 49152
	s_add_u32 s82, s82, s76
	s_waitcnt lgkmcnt(8)
	buffer_load_dwordx4 v244, s[16:19], s82 offen offset:0 lds
	buffer_load_dwordx4 v245, s[16:19], s82 offen offset:1024 lds
	buffer_load_dwordx4 v246, s[16:19], s82 offen offset:2048 lds
	buffer_load_dwordx4 v247, s[16:19], s82 offen offset:3072 lds
	buffer_load_dword v217, v241, s[12:15], 0 offen sc1
	v_lshlrev_b32 v220, 4, v0
	v_and_b32 v222, 15, v0
	v_lshrrev_b32 v222, 2, v222
	v_lshrrev_b32 v223, 5, v0
	v_lshl_add_u32 v223, v223, 2, v222
	v_lshlrev_b32 v223, 7, v223
	v_lshrrev_b32 v222, 1, v222
	v_lshl_or_b32 v223, v222, 6, v223
	v_lshrrev_b32 v222, 4, v0
	v_and_b32 v222, 1, v222
	v_lshl_or_b32 v223, v222, 5, v223
	v_and_b32 v222, 3, v0
	v_lshl_or_b32 v223, v222, 3, v223
	v_add_u32 v250, s81, v223
	v_xor_b32 v223, 64, v223
	v_add_u32 v251, s81, v223
	v_lshrrev_b32 v222, 3, v0
	v_mul_u32_u24 v222, 896, v222
	v_and_b32 v223, 7, v0
	v_lshl_add_u32 v221, v223, 4, v222
	s_lshl_b32 s56, s35, 6
	s_lshl_b32 s57, s32, 3
	s_add_u32 s56, s56, s57
	s_mul_i32 s56, s56, 896
	s_lshl_b32 s57, s36, 7
	s_add_u32 s44, s56, s57
	s_mul_i32 s41, s35, 229376
	s_add_u32 s41, s41, 0
	s_lshl_b32 s56, s32, 13
	s_add_u32 s40, s41, s56
	s_lshl_b32 s56, s35, 16
	s_add_u32 s56, s56, 7340032
	s_mov_b32 s42, 28672
	s_mov_b32 s43, 20480
	s_cmp_eq_u32 s32, 3
	s_cselect_b32 s40, s56, s40
	s_cselect_b32 s42, 4096, s42
	s_cselect_b32 s43, 4096, s43
	s_cselect_b32 s45, 0, 256
	v_mov_b32 v240, 2.0
	s_waitcnt lgkmcnt(0)
	s_waitcnt vmcnt(10)
	s_branch L_f_p1done
L_rdym_slow:
	s_mov_b32 s50, 262144
L_rdym_loop:
	buffer_load_dword v243, off, s[20:23], 0 sc1
	s_waitcnt vmcnt(0)
	v_readfirstlane_b32 s51, v243
	s_sub_u32 s50, s50, 1
	s_cbranch_scc1 L_rdym_back
	s_cmp_eq_u32 s51, 0
	s_cbranch_scc1 L_rdym_loop
	s_branch L_rdym_back
L_rdya_slow:
	s_mov_b32 s50, 262144
L_rdya_loop:
	buffer_load_dword v243, off, s[20:23], 0 sc1
	s_waitcnt vmcnt(0)
	v_readfirstlane_b32 s51, v243
	s_sub_u32 s50, s50, 1
	s_cbranch_scc1 L_rdya_back
	s_cmp_eq_u32 s51, 0
	s_cbranch_scc1 L_rdya_loop
	s_branch L_rdya_back
L_p2_w3:
	s_waitcnt vmcnt(11) lgkmcnt(0)
	v_mfma_f32_32x32x16_bf16 v[4:19], v[196:199], v[148:151], v[4:19]
	s_add_u32 s47, s44, 0
	ds_read_b64_tr_b16 v[204:205], v248 offset:18432
	buffer_load_dwordx4 v[212:215], v221, s[4:7], s47 offen
	ds_read_b64_tr_b16 v[206:207], v248 offset:19456
	ds_read_b64_tr_b16 v[208:209], v249 offset:18432
	v_mfma_f32_32x32x16_bf16 v[36:51], v[200:203], v[148:151], v[36:51]
	s_add_u32 s47, s44, 28672
	ds_read_b64_tr_b16 v[210:211], v249 offset:19456
	buffer_load_dwordx4 v[216:219], v221, s[4:7], s47 offen
	v_and_b32 v222, 31, v0
	v_lshlrev_b32 v227, 8, v222
	v_mfma_f32_32x32x16_bf16 v[20:35], v[196:199], v[152:155], v[20:35]
	v_add_u32 v227, s81, v227
	v_and_b32 v222, 15, v0
	v_lshrrev_b32 v224, 5, v0
	v_mfma_f32_32x32x16_bf16 v[52:67], v[200:203], v[152:155], v[52:67]
	s_waitcnt vmcnt(11) lgkmcnt(0)
	v_mfma_f32_32x32x16_bf16 v[4:19], v[204:207], v[156:159], v[4:19]
	ds_read_b64_tr_b16 v[196:197], v248 offset:32768
	ds_read_b64_tr_b16 v[198:199], v248 offset:33792
	ds_read_b64_tr_b16 v[200:201], v249 offset:32768
	ds_read_b64_tr_b16 v[202:203], v249 offset:33792
	v_xor_b32 v222, v222, v224
	v_lshl_add_u32 v227, v222, 4, v227
	v_mfma_f32_32x32x16_bf16 v[36:51], v[208:211], v[156:159], v[36:51]
	v_xor_b32 v228, 32, v227
	v_xor_b32 v229, 64, v227
	v_xor_b32 v230, 96, v227
	v_mfma_f32_32x32x16_bf16 v[20:35], v[204:207], v[160:163], v[20:35]
	v_mfma_f32_32x32x16_bf16 v[52:67], v[208:211], v[160:163], v[52:67]
	s_waitcnt vmcnt(8) lgkmcnt(0)
	v_mfma_f32_32x32x16_bf16 v[4:19], v[196:199], v[164:167], v[4:19]
	ds_read_b64_tr_b16 v[204:205], v248 offset:34816
	ds_read_b64_tr_b16 v[206:207], v248 offset:35840
	ds_read_b64_tr_b16 v[208:209], v249 offset:34816
	ds_read_b64_tr_b16 v[210:211], v249 offset:35840
	v_xor_b32 v231, 128, v227
	v_xor_b32 v232, 160, v227
	v_mfma_f32_32x32x16_bf16 v[36:51], v[200:203], v[164:167], v[36:51]
	v_xor_b32 v233, 192, v227
	v_xor_b32 v234, 224, v227
	v_lshrrev_b32 v222, 3, v0
	v_mfma_f32_32x32x16_bf16 v[20:35], v[196:199], v[168:171], v[20:35]
	v_mfma_f32_32x32x16_bf16 v[52:67], v[200:203], v[168:171], v[52:67]
	s_waitcnt vmcnt(6) lgkmcnt(0)
	v_mfma_f32_32x32x16_bf16 v[4:19], v[204:207], v[172:175], v[4:19]
	ds_read_b64_tr_b16 v[196:197], v250 offset:0
	s_lshl_b32 s49, s32, 3
	ds_read_b64_tr_b16 v[198:199], v250 offset:1024
	ds_read_b64_tr_b16 v[200:201], v251 offset:0
	ds_read_b64_tr_b16 v[202:203], v251 offset:1024
	v_add_u32 v222, s49, v222
	v_mfma_f32_32x32x16_bf16 v[36:51], v[208:211], v[172:175], v[36:51]
	v_and_b32 v223, 7, v0
	v_lshlrev_b32 v223, 1, v223
	v_and_b32 v224, 15, v222
	v_mfma_f32_32x32x16_bf16 v[20:35], v[204:207], v[176:179], v[20:35]
	v_mfma_f32_32x32x16_bf16 v[52:67], v[208:211], v[176:179], v[52:67]
	s_waitcnt vmcnt(4) lgkmcnt(0)
	v_mfma_f32_32x32x16_bf16 v[4:19], v[196:199], v[180:183], v[4:19]
	ds_read_b64_tr_b16 v[204:205], v250 offset:2048
	ds_read_b64_tr_b16 v[206:207], v250 offset:3072
	ds_read_b64_tr_b16 v[208:209], v251 offset:2048
	ds_read_b64_tr_b16 v[210:211], v251 offset:3072
	v_xor_b32 v224, v224, v223
	v_lshlrev_b32 v224, 4, v224
	v_mfma_f32_32x32x16_bf16 v[36:51], v[200:203], v[180:183], v[36:51]
	v_lshl_add_u32 v225, v222, 8, v224
	v_lshrrev_b32 v224, 1, v222
	v_xor_b32 v226, v224, v223
	v_mfma_f32_32x32x16_bf16 v[20:35], v[196:199], v[184:187], v[20:35]
	v_mfma_f32_32x32x16_bf16 v[52:67], v[200:203], v[184:187], v[52:67]
	s_waitcnt vmcnt(2) lgkmcnt(0)
	v_mfma_f32_32x32x16_bf16 v[4:19], v[204:207], v[188:191], v[4:19]
	v_lshlrev_b32 v226, 4, v226
	v_and_b32 v222, 1, v222
	v_lshl_add_u32 v224, v222, 5, v224
	v_lshl_add_u32 v226, v224, 8, v226
	v_xor_b32 v235, 16, v225
	v_mfma_f32_32x32x16_bf16 v[36:51], v[208:211], v[188:191], v[36:51]
	v_xor_b32 v236, 16, v226
	v_mfma_f32_32x32x16_bf16 v[20:35], v[204:207], v[192:195], v[20:35]
	v_mfma_f32_32x32x16_bf16 v[52:67], v[208:211], v[192:195], v[52:67]
	s_nop 2
	ds_write_b128 v227, v[4:7] offset:0
	ds_write_b128 v228, v[8:11] offset:0
	ds_write_b128 v229, v[12:15] offset:0
	ds_write_b128 v230, v[16:19] offset:0
	s_nop 1
	ds_write_b128 v231, v[36:39] offset:0
	ds_write_b128 v232, v[40:43] offset:0
	ds_write_b128 v233, v[44:47] offset:0
	ds_write_b128 v234, v[48:51] offset:0
	ds_write_b128 v227, v[20:23] offset:8192
	ds_write_b128 v228, v[24:27] offset:8192
	ds_write_b128 v229, v[28:31] offset:8192
	ds_write_b128 v230, v[32:35] offset:8192
	ds_write_b128 v231, v[52:55] offset:8192
	ds_write_b128 v232, v[56:59] offset:8192
	ds_write_b128 v233, v[60:63] offset:8192
	ds_write_b128 v234, v[64:67] offset:8192
	s_waitcnt vmcnt(1)
	v_lshlrev_b32 v164, 16, v212
	v_and_b32 v165, 0xffff0000, v212
	v_lshlrev_b32 v166, 16, v213
	v_and_b32 v167, 0xffff0000, v213
	v_lshlrev_b32 v168, 16, v214
	v_and_b32 v169, 0xffff0000, v214
	v_lshlrev_b32 v170, 16, v215
	v_and_b32 v171, 0xffff0000, v215
	s_waitcnt vmcnt(0)
	v_lshlrev_b32 v172, 16, v216
	v_and_b32 v173, 0xffff0000, v216
	v_lshlrev_b32 v174, 16, v217
	v_and_b32 v175, 0xffff0000, v217
	v_lshlrev_b32 v176, 16, v218
	v_and_b32 v177, 0xffff0000, v218
	v_lshlrev_b32 v178, 16, v219
	v_and_b32 v179, 0xffff0000, v219
	s_branch L_p2_bar
L_late_slow:
	s_mov_b32 s50, 262144
L_late_loop:
	buffer_load_dword v242, v241, s[12:15], s45 offen sc1
	s_waitcnt vmcnt(0)
	v_readfirstlane_b32 s51, v242
	s_sub_u32 s50, s50, 1
	s_cbranch_scc1 L_late_back
	s_cmp_lt_u32 s51, 32
	s_cbranch_scc1 L_late_loop
	s_branch L_late_back
L_early_slow:
	s_mov_b32 s50, 262144
	buffer_load_dword v242, v241, s[12:15], 0 offen sc1
	s_waitcnt vmcnt(2)
	v_readfirstlane_b32 s51, v216
	s_cmp_ge_u32 s51, 32
	s_cbranch_scc1 L_early_back
	buffer_load_dword v216, v241, s[12:15], 0 offen sc1
	s_waitcnt vmcnt(2)
	v_readfirstlane_b32 s51, v217
	s_cmp_ge_u32 s51, 32
	s_cbranch_scc1 L_early_back
	buffer_atomic_add v243, v240, s[12:15], 0 offen offset:256 sc1
	s_nop 1
	v_mov_b32 v240, 2.0
L_early_loop:
	buffer_load_dword v217, v241, s[12:15], 0 offen sc1
	s_waitcnt vmcnt(2)
	v_readfirstlane_b32 s51, v242
	s_cmp_ge_u32 s51, 32
	s_cbranch_scc1 L_early_back
	buffer_load_dword v242, v241, s[12:15], 0 offen sc1
	s_waitcnt vmcnt(2)
	v_readfirstlane_b32 s51, v216
	s_cmp_ge_u32 s51, 32
	s_cbranch_scc1 L_early_back
	buffer_load_dword v216, v241, s[12:15], 0 offen sc1
	s_waitcnt vmcnt(2)
	v_readfirstlane_b32 s51, v217
	s_cmp_ge_u32 s51, 32
	s_cbranch_scc1 L_early_back
	s_sub_u32 s50, s50, 1
	s_cbranch_scc0 L_early_loop
	s_branch L_early_back
L_code_end:
	s_endpgm

.section .rodata,"a"
.p2align 6
.amdhsa_kernel recurrent_scan__sliding_local_dilated__dense_activation_mish__prompt_kernel
  .amdhsa_next_free_vgpr 512
  .amdhsa_next_free_sgpr 102
  .amdhsa_accum_offset 256
  .amdhsa_group_segment_fixed_size 0
  .amdhsa_kernarg_size 80
  .amdhsa_user_sgpr_count 2
  .amdhsa_user_sgpr_kernarg_segment_ptr 1
  .amdhsa_system_sgpr_workgroup_id_x 1
.end_amdhsa_kernel
```
